```python
import torch

def _softmax(x, axis=-1):
    return torch.softmax(x, dim=axis)
def _gelu(x):
    return torch.nn.functional.gelu(x, approximate="tanh")
def _silu(x):
    return torch.nn.functional.silu(x)
def _sigmoid(x):
    return torch.sigmoid(x)
def _layernorm(x, axis=-1, eps=1e-5):
    m = x.mean(dim=axis, keepdim=True)
    v = x.var(dim=axis, keepdim=True, unbiased=False)
    return (x - m) / torch.sqrt(v + eps)
def _scatter_add(tgt, idx, src, axis=0):
    return tgt.clone().index_add_(axis, idx, src)
def _segment_sum(src, seg, n):
    out = torch.zeros((n,) + src.shape[1:], dtype=src.dtype)
    return out.index_add_(0, seg, src)
def _pad(x, pw):
    flat = tuple(v for pair in reversed(pw) for v in pair)
    return torch.nn.functional.pad(x, flat)

kernel_name = 'standalone__normalfloat_lut_nf4__prompt'

def setup_inputs():

    _w = (lambda a: (lambda t: t.to(torch.bfloat16) if t.is_floating_point() else t)(torch.as_tensor(a)))
    B, S, D, F = 1, 2048, 576, 4608
    G = -1 if -1 > 0 else D
    D = (D // G) * G
    ng = D // G
    qw = torch.randint(0, 16, (D, F)).to(torch.int64)
    return {
        "x": _w((lambda *s: torch.randn(*s, dtype=torch.bfloat16) * 0.05)(B, S, D)),
        "qw": _w(qw),
        "absmax": _w(torch.abs((lambda *s: torch.randn(*s, dtype=torch.bfloat16) * 0.05)(ng, F)).to(float) + 0.01),
    }

def reference(x, qw, absmax):
    NF4 = torch.as_tensor([
        -1.0, -0.6961928009986877, -0.5250730514526367, -0.39491748809814453,
        -0.28444138169288635, -0.18477343022823334, -0.09105003625154495, 0.0,
        0.07958029955625534, 0.16093020141124725, 0.24611230194568634,
        0.33791524171829224, 0.44070982933044434, 0.5626170039176941,
        0.7229568362236023, 1.0,
    ])
    D, F = qw.shape[0], qw.shape[1]
    ng = absmax.shape[0]
    G = D // ng
    w = (lambda x, dt: x.to(dt))(NF4[qw], x.dtype)
    s = (lambda x, n, axis: torch.repeat_interleave(x, n, dim=axis))(absmax, G, axis=0)
    w = w * s
    return torch.einsum("bsd,df->bsf", x, w)
```

```asm
; @launch grid=(252,1,1) block=(512,1,1) lds=163840
.amdgcn_target "amdgcn-amd-amdhsa--gfx950"
.text
.globl standalone__normalfloat_lut_nf4__prompt_kernel
.p2align 12
.p2align 8
.type standalone__normalfloat_lut_nf4__prompt_kernel,@function
standalone__normalfloat_lut_nf4__prompt_kernel:
 s_load_dwordx4 s[4:7], s[0:1], 0
 s_load_dwordx4 s[8:11], s[0:1], 16
 s_cmp_ge_u32 s2, 252
 s_cbranch_scc1 L_end
 v_lshrrev_b32 v2, 6, v0
 v_and_b32 v1, 63, v0
 s_and_b32 s30, s2, 7
 v_readfirstlane_b32 s50, v2
 s_lshr_b32 s31, s2, 3
 s_and_b32 s34, s2, 3
 s_mul_i32 s34, s34, 63
 s_and_b32 s35, s2, 4
 s_lshl_b32 s35, s35, 3
 s_add_u32 s34, s34, s35
 s_add_u32 s34, s34, s31
 s_mul_i32 s35, s34, 9363
 s_lshr_b32 s35, s35, 16
 s_mul_i32 s36, s35, 7
 s_sub_u32 s36, s34, s36
 s_xor_b32 s50, s50, 4
 s_and_b32 s51, s50, 3
 s_cmp_ge_u32 s50, 4
 s_cbranch_scc1 L_prod
 s_cmp_eq_u32 s50, 3
 s_cbranch_scc1 L_cons
 v_mov_b64 v[16:17], 0
 v_mov_b64 v[18:19], 0
 v_mov_b64 v[20:21], 0
 v_mov_b64 v[22:23], 0
 v_mov_b64 v[24:25], 0
 v_mov_b64 v[26:27], 0
 v_mov_b64 v[28:29], 0
 v_mov_b64 v[30:31], 0
 v_mov_b64 v[32:33], 0
 v_mov_b64 v[34:35], 0
 v_mov_b64 v[36:37], 0
 v_mov_b64 v[38:39], 0
 v_mov_b64 v[40:41], 0
 v_mov_b64 v[42:43], 0
 v_mov_b64 v[44:45], 0
 v_mov_b64 v[46:47], 0
 s_mov_b64 exec, 0
 s_cmp_eq_u32 s50, 1
 s_cbranch_scc1 L_dry1
 s_cmp_eq_u32 s50, 2
 s_cbranch_scc1 L_dry2
 s_branch L_dry0
L_prod:
 v_lshrrev_b32 v12, 5, v1
 v_mul_u32_u24 v12, 147456, v12
 v_and_b32 v13, 31, v1
 v_lshl_add_u32 v12, v13, 4, v12
 s_lshl_b32 s38, s36, 2
 s_lshr_b32 s38, 0x606055, s38
 s_and_b32 s38, s38, 15
 s_add_u32 s38, s38, s30
 s_sub_u32 s52, s38, 9
 s_cselect_b32 s38, s38, s52
 s_lshl_b32 s52, s38, 2
 s_add_u32 s52, s52, s51
 s_mul_i32 s52, s52, 294912
 s_lshl_b32 s39, s35, 9
 s_add_u32 s39, s39, s52
 v_add_u32 v2, s39, v12
 s_movk_i32 s94, 18432
 s_add_u32 s95, s94, s94
 s_add_u32 s96, s95, s94
 s_add_u32 s97, s96, s94
 s_add_u32 s98, s97, s94
 s_add_u32 s99, s98, s94
 s_add_u32 s100, s99, s94
 s_mov_b32 s22, 10616832
 s_mov_b32 s23, 0x74fac
 s_mov_b32 s28, s38
 s_mov_b32 s12, 4285530112
 s_mov_b32 s13, 1179648
 s_waitcnt lgkmcnt(0)
 s_mov_b32 s20, s6
 s_mov_b32 s21, s7
 s_mul_i32 s49, s36, 331776
 s_mul_i32 s48, s51, 92160
 s_add_u32 s49, s49, s48
 s_load_dword s48, s[4:5], s49
 buffer_load_format_d16_xyzw v[32:33], v2, s[20:23], 0 offen
 buffer_load_format_d16_xyzw v[34:35], v2, s[20:23], s94 offen
 buffer_load_format_d16_xyzw v[36:37], v2, s[20:23], s95 offen
 buffer_load_format_d16_xyzw v[38:39], v2, s[20:23], s96 offen
 buffer_load_format_d16_xyzw v[40:41], v2, s[20:23], s97 offen
 buffer_load_format_d16_xyzw v[42:43], v2, s[20:23], s98 offen
 buffer_load_format_d16_xyzw v[44:45], v2, s[20:23], s99 offen
 buffer_load_format_d16_xyzw v[46:47], v2, s[20:23], s100 offen
 s_cmp_eq_u32 s28, 8
 s_cselect_b32 s3, s12, s13
 s_add_u32 s28, s28, 1
 v_add_u32 v2, s3, v2
 s_mul_i32 s37, s36, 18
 s_min_u32 s39, s36, 2
 s_add_u32 s37, s37, s39
 s_mov_b32 s16, s4
 s_mov_b32 s17, s5
 s_mov_b32 s18, 2359296
 s_mov_b32 s19, 0x20000
 s_lshl_b32 s29, s38, 7
 s_mov_b32 s33, s29
 v_lshrrev_b32 v12, 3, v1
 v_lshrrev_b32 v13, 1, v12
 v_and_b32 v14, 7, v1
 v_xor_b32 v13, v13, v14
 v_lshlrev_b32 v13, 4, v13
 v_mul_u32_u24 v12, 1152, v12
 s_and_b32 s58, s51, 1
 s_lshl_b32 s59, s58, 6
 v_xor_b32 v13, s59, v13
 s_mul_i32 s52, s37, s94
 s_mul_i32 s55, s51, 9216
 s_add_u32 s52, s52, s55
 v_add3_u32 v3, v12, v13, s52
 s_lshl_b32 s56, s51, 10
 s_add_u32 s40, s56, 0
 s_add_u32 s41, s56, 86016
 s_add_u32 s42, s56, 122880
 s_add_u32 s43, s56, 159744
 s_or_b32 s32, s36, s51
 s_cmp_lt_u32 s32, 2
 s_cselect_b32 s32, 1, 0
 s_cmp_eq_u32 s32, 0
 s_cbranch_scc1 L_e1
 s_mov_b32 m0, s43
 s_add_u32 s3, s33, 331776
 buffer_load_dwordx4 v3, s[16:19], s3 offen lds
 s_add_u32 s33, s33, 128
 s_cmp_eq_u32 s33, 1152
 s_cselect_b32 s33, 0, s33
 s_xor_b32 s43, s43, 2048
L_e1:
 s_mov_b32 s53, s40
 s_mov_b32 s57, s29
 s_add_u32 s29, s29, 128
 s_cmp_eq_u32 s29, 1152
 s_cselect_b32 s29, 0, s29
 s_mov_b32 s3, s40
 s_mov_b32 s40, s41
 s_mov_b32 s41, s42
 s_mov_b32 s42, s3
 s_mov_b32 m0, s53
 s_add_u32 s53, s53, 36864
 buffer_load_dwordx4 v3, s[16:19], s57 offen lds
 s_addk_i32 m0, 4096
 s_add_u32 s57, s57, s95
 buffer_load_dwordx4 v3, s[16:19], s57 offen lds
 s_addk_i32 m0, 4096
 s_add_u32 s57, s57, s95
 buffer_load_dwordx4 v3, s[16:19], s57 offen lds
 s_addk_i32 m0, 4096
 s_add_u32 s57, s57, s95
 buffer_load_dwordx4 v3, s[16:19], s57 offen lds
 s_addk_i32 m0, 4096
 s_add_u32 s57, s57, s95
 buffer_load_dwordx4 v3, s[16:19], s57 offen lds
 s_addk_i32 m0, 4096
 s_add_u32 s57, s57, s95
 buffer_load_dwordx4 v3, s[16:19], s57 offen lds
 s_addk_i32 m0, 4096
 s_add_u32 s57, s57, s95
 buffer_load_dwordx4 v3, s[16:19], s57 offen lds
 s_addk_i32 m0, 4096
 s_add_u32 s57, s57, s95
 buffer_load_dwordx4 v3, s[16:19], s57 offen lds
 s_addk_i32 m0, 4096
 s_add_u32 s57, s57, s95
 buffer_load_dwordx4 v3, s[16:19], s57 offen lds
 s_add_u32 s57, s57, s95
 s_branch L_p2
L_cons:
 v_mov_b32 v32, 0x414040bf
 v_mov_b32 v33, 0xff4241be
 v_mov_b32 v34, 0xc13e3e3d
 v_mov_b32 v35, 0xc0c0c03e
 v_mov_b32 v36, 0xcaf9327f
 v_mov_b32 v37, 0xff45c292
 v_mov_b32 v38, 0x5283daa3
 v_mov_b32 v39, 0x7fc6efe2
 v_and_b32 v16, 15, v1
 v_lshrrev_b32 v40, 4, v1
 v_lshl_or_b32 v40, v40, 8, v16
 v_and_b32 v46, 7, v1
 v_lshlrev_b32 v46, 4, v46
 v_lshl_add_u32 v46, v1, 7, v46
 v_add_u32 v46, 36864, v46
 s_mov_b32 s28, 0x05010400
 s_mov_b32 s29, 4
L_lut:
 v_xor_b32 v41, 0x0808, v40
 v_perm_b32 v42, v33, v32, v40
 v_perm_b32 v43, v35, v34, v41
 v_perm_b32 v44, v37, v36, v40
 v_perm_b32 v45, v39, v38, v41
 v_xor_b32 v42, v42, v43
 v_xor_b32 v44, v44, v45
 v_perm_b32 v48, v42, v44, s28
 v_mov_b32 v49, v48
 v_mov_b32 v50, v48
 v_mov_b32 v51, v48
 ds_write_b128 v46, v[48:51]
 v_xor_b32 v47, 16, v46
 ds_write_b128 v47, v[48:51]
 v_xor_b32 v47, 32, v46
 ds_write_b128 v47, v[48:51]
 v_xor_b32 v47, 48, v46
 ds_write_b128 v47, v[48:51]
 v_xor_b32 v47, 64, v46
 ds_write_b128 v47, v[48:51]
 v_xor_b32 v47, 80, v46
 ds_write_b128 v47, v[48:51]
 v_xor_b32 v47, 96, v46
 ds_write_b128 v47, v[48:51]
 v_xor_b32 v47, 112, v46
 ds_write_b128 v47, v[48:51]
 v_add_u32 v40, 0x400, v40
 v_add_u32 v46, 8192, v46
 s_waitcnt lgkmcnt(0)
 s_sub_u32 s29, s29, 1
 s_cmp_lg_u32 s29, 0
 s_cbranch_scc1 L_lut
L_dry_done:
 s_mov_b64 exec, -1
 s_setprio 1
 v_and_b32 v16, 15, v1
 v_lshrrev_b32 v17, 4, v1
 s_mul_i32 s37, s36, 18
 s_min_u32 s39, s36, 2
 s_add_u32 s37, s37, s39
 s_lshl_b32 s52, s35, 8
 s_lshl_b32 s53, s51, 6
 s_add_u32 s52, s52, s53
 v_lshlrev_b32 v18, 2, v16
 v_add_u32 v18, s52, v18
 v_lshrrev_b32 v52, 1, v16
 v_xor_b32 v52, v52, v17
 v_lshlrev_b32 v52, 4, v52
 v_lshl_add_u32 v2, v16, 7, v52
 v_xor_b32 v3, 64, v2
 v_add_u32 v0, 159744, v2
 v_and_b32 v52, 1, v16
 v_lshlrev_b32 v52, 3, v52
 v_lshl_add_u32 v52, v17, 4, v52
 v_lshrrev_b32 v4, 1, v16
 v_add_u32 v52, v52, v4
 s_lshl_b32 s57, s51, 10
 s_add_u32 s53, s57, 69632
 v_lshlrev_b32 v52, 4, v52
 v_add_u32 v4, s53, v52
 v_and_b32 v52, 31, v1
 v_lshlrev_b32 v52, 2, v52
 v_add_u32 v1, 36864, v52
 s_cmp_lt_u32 s36, 2
 s_cselect_b32 s55, 18, 17
 s_add_u32 s52, s37, s55
 s_mul_i32 s52, s52, 147456
 v_mul_u32_u24 v52, 36864, v17
 v_add3_u32 v7, v52, v18, s52
 s_movk_i32 s52, 9216
 s_movk_i32 s53, 18432
 s_movk_i32 s54, 27648
 s_waitcnt lgkmcnt(0)
 s_mov_b32 s24, s8
 s_mov_b32 s25, s9
 s_mov_b32 s26, 9216
 s_mov_b32 s27, 0x20000
 buffer_load_dword v6, v18, s[24:27], 0 offen
 s_mov_b32 s24, s10
 s_mov_b32 s25, s11
 s_mov_b32 s26, 18874368
 s_add_u32 m0, s57, 20480
 s_mov_b32 s43, 0xffff
 v_mov_b64 v[16:17], 0
 v_mov_b64 v[18:19], 0
 v_mov_b64 v[20:21], 0
 v_mov_b64 v[22:23], 0
 v_mov_b64 v[24:25], 0
 v_mov_b64 v[26:27], 0
 v_mov_b64 v[28:29], 0
 v_mov_b64 v[30:31], 0
 v_mov_b64 v[32:33], 0
 v_mov_b64 v[34:35], 0
 v_mov_b64 v[36:37], 0
 v_mov_b64 v[38:39], 0
 v_mov_b64 v[40:41], 0
 v_mov_b64 v[42:43], 0
 v_mov_b64 v[44:45], 0
 v_mov_b64 v[46:47], 0
 v_mov_b64 v[48:49], 0
 v_mov_b64 v[50:51], 0
 v_mov_b64 v[52:53], 0
 v_mov_b64 v[54:55], 0
 v_mov_b64 v[56:57], 0
 v_mov_b64 v[58:59], 0
 v_mov_b64 v[60:61], 0
 v_mov_b64 v[62:63], 0
 v_mov_b64 v[104:105], 0
 v_mov_b64 v[106:107], 0
 v_mov_b64 v[108:109], 0
 v_mov_b64 v[110:111], 0
 v_mov_b64 v[112:113], 0
 v_mov_b64 v[114:115], 0
 v_mov_b64 v[116:117], 0
 v_mov_b64 v[118:119], 0
 v_mov_b64 v[120:121], 0
 v_mov_b64 v[122:123], 0
 v_mov_b64 v[124:125], 0
 v_mov_b64 v[126:127], 0
 v_mov_b64 v[128:129], 0
 v_mov_b64 v[130:131], 0
 v_mov_b64 v[132:133], 0
 v_mov_b64 v[134:135], 0
 v_mov_b64 v[136:137], 0
 v_mov_b64 v[138:139], 0
 v_mov_b64 v[140:141], 0
 v_mov_b64 v[142:143], 0
 v_mov_b64 v[144:145], 0
 v_mov_b64 v[146:147], 0
 v_mov_b64 v[148:149], 0
 v_mov_b64 v[150:151], 0
 v_mov_b64 v[152:153], 0
 v_mov_b64 v[154:155], 0
 v_mov_b64 v[156:157], 0
 v_mov_b64 v[158:159], 0
 v_mov_b64 v[160:161], 0
 v_mov_b64 v[162:163], 0
 v_mov_b64 v[164:165], 0
 v_mov_b64 v[166:167], 0
 v_mov_b64 v[168:169], 0
 v_mov_b64 v[170:171], 0
 v_mov_b64 v[172:173], 0
 v_mov_b64 v[174:175], 0
 v_mov_b64 v[176:177], 0
 v_mov_b64 v[178:179], 0
 v_mov_b64 v[180:181], 0
 v_mov_b64 v[182:183], 0
 v_mov_b64 v[184:185], 0
 v_mov_b64 v[186:187], 0
 v_mov_b64 v[188:189], 0
 v_mov_b64 v[190:191], 0
 v_mov_b64 v[192:193], 0
 v_mov_b64 v[194:195], 0
 v_mov_b64 v[196:197], 0
 v_mov_b64 v[198:199], 0
 v_mov_b64 v[200:201], 0
 v_mov_b64 v[202:203], 0
 v_mov_b64 v[204:205], 0
 v_mov_b64 v[206:207], 0
 v_mov_b64 v[208:209], 0
 v_mov_b64 v[210:211], 0
 v_mov_b64 v[212:213], 0
 v_mov_b64 v[214:215], 0
 v_mov_b64 v[216:217], 0
 v_mov_b64 v[218:219], 0
 v_mov_b64 v[220:221], 0
 v_mov_b64 v[222:223], 0
 v_mov_b64 v[224:225], 0
 v_mov_b64 v[226:227], 0
 v_mov_b64 v[228:229], 0
 v_mov_b64 v[230:231], 0
 v_mov_b64 v[232:233], 0
 v_mov_b64 v[234:235], 0
 v_mov_b64 v[236:237], 0
 v_mov_b64 v[238:239], 0
 v_mov_b64 v[240:241], 0
 v_mov_b64 v[242:243], 0
 v_mov_b64 v[244:245], 0
 v_mov_b64 v[246:247], 0
 v_mov_b64 v[248:249], 0
 v_mov_b64 v[250:251], 0
 v_mov_b64 v[252:253], 0
 v_mov_b64 v[254:255], 0
 s_mov_b32 s40, 86016
 s_mov_b32 s41, 36864
 s_mov_b32 s42, 4294844416
 s_mov_b32 s39, 4294959104
 s_mov_b32 s34, 6
 s_waitcnt lgkmcnt(0)
 s_barrier
 ds_read_b128 v[8:11], v4 offset:0
 ds_read_b128 v[12:15], v4 offset:4096
 v_add_u32 v4, 8192, v4
 s_waitcnt lgkmcnt(1)
 v_and_b32 v48, s43, v8
 v_and_b32 v49, s43, v9
 v_and_b32 v50, s43, v10
 v_and_b32 v51, s43, v11
 v_lshrrev_b32 v52, 16, v8
 v_lshrrev_b32 v53, 16, v9
 v_lshrrev_b32 v54, 16, v10
 v_lshrrev_b32 v55, 16, v11
 ds_read_b32 v48, v48 offset:36864
 ds_read_b32 v49, v49 offset:36864
 ds_read_b32 v50, v50 offset:36864
 ds_read_b32 v51, v51 offset:36864
 ds_read_b32 v52, v52 offset:36864
 ds_read_b32 v53, v53 offset:36864
 ds_read_b32 v54, v54 offset:36864
 ds_read_b32 v55, v55 offset:36864
 s_waitcnt lgkmcnt(0)
 s_cmp_ge_u32 s36, 2
 s_cbranch_scc1 L_k18
L_k19:
 s_barrier
L_k19_t:
 v_mfma_f32_16x16x32_bf16 v[204:207], v[16:19], v[60:63], v[204:207]
 ds_read_b128 v[40:43], v0
 v_xor_b32 v0, 64, v0
 v_mfma_f32_16x16x32_bf16 v[208:211], v[20:23], v[56:59], v[208:211]
 ds_read_b128 v[44:47], v2 offset:0
 ds_read_b128 v[64:67], v2 offset:2048
 v_mfma_f32_16x16x32_bf16 v[212:215], v[20:23], v[60:63], v[212:215]
 ds_read_b128 v[68:71], v2 offset:4096
 v_mfma_f32_16x16x32_bf16 v[216:219], v[24:27], v[56:59], v[216:219]
 ds_read_b128 v[72:75], v2 offset:6144
 ds_read_b128 v[76:79], v2 offset:8192
 v_mfma_f32_16x16x32_bf16 v[220:223], v[24:27], v[60:63], v[220:223]
 ds_read_b128 v[16:19], v2 offset:10240
 v_mfma_f32_16x16x32_bf16 v[224:227], v[28:31], v[56:59], v[224:227]
 ds_read_b128 v[20:23], v2 offset:12288
 ds_read_b128 v[24:27], v2 offset:14336
 v_mfma_f32_16x16x32_bf16 v[228:231], v[28:31], v[60:63], v[228:231]
 v_mfma_f32_16x16x32_bf16 v[232:235], v[32:35], v[56:59], v[232:235]
 ds_read_b128 v[28:31], v2 offset:16384
 v_mfma_f32_16x16x32_bf16 v[236:239], v[32:35], v[60:63], v[236:239]
 v_mfma_f32_16x16x32_bf16 v[240:243], v[36:39], v[56:59], v[240:243]
 ds_read_b128 v[32:35], v2 offset:18432
 v_mfma_f32_16x16x32_bf16 v[244:247], v[36:39], v[60:63], v[244:247]
 s_waitcnt lgkmcnt(9)
 v_mfma_f32_16x16x32_bf16 v[248:251], v[40:43], v[48:51], v[248:251]
 ds_read_b128 v[36:39], v2 offset:20480
 v_mfma_f32_16x16x32_bf16 v[252:255], v[40:43], v[52:55], v[252:255]
 v_mfma_f32_16x16x32_bf16 v[104:107], v[44:47], v[48:51], v[104:107]
 ds_read_b128 v[40:43], v2 offset:22528
 v_and_b32 v56, s43, v12
 v_mfma_f32_16x16x32_bf16 v[108:111], v[44:47], v[52:55], v[108:111]
 v_and_b32 v57, s43, v13
 s_waitcnt lgkmcnt(9)
 v_mfma_f32_16x16x32_bf16 v[112:115], v[64:67], v[48:51], v[112:115]
 ds_read_b128 v[44:47], v2 offset:24576
 ds_read_b32 v56, v56 offset:36864
 v_mfma_f32_16x16x32_bf16 v[116:119], v[64:67], v[52:55], v[116:119]
 v_and_b32 v58, s43, v14
 v_mfma_f32_16x16x32_bf16 v[120:123], v[68:71], v[48:51], v[120:123]
 ds_read_b128 v[64:67], v2 offset:26624
 ds_read_b32 v57, v57 offset:36864
 v_mfma_f32_16x16x32_bf16 v[124:127], v[68:71], v[52:55], v[124:127]
 v_and_b32 v59, s43, v15
 s_waitcnt lgkmcnt(11)
 v_mfma_f32_16x16x32_bf16 v[128:131], v[72:75], v[48:51], v[128:131]
 ds_read_b128 v[68:71], v2 offset:28672
 ds_read_b32 v58, v58 offset:36864
 v_mfma_f32_16x16x32_bf16 v[132:135], v[72:75], v[52:55], v[132:135]
 v_lshrrev_b32 v60, 16, v12
 v_mfma_f32_16x16x32_bf16 v[136:139], v[76:79], v[48:51], v[136:139]
 ds_read_b128 v[72:75], v2 offset:30720
 ds_read_b32 v59, v59 offset:36864
 v_mfma_f32_16x16x32_bf16 v[140:143], v[76:79], v[52:55], v[140:143]
 v_lshrrev_b32 v61, 16, v13
 s_waitcnt lgkmcnt(13)
 v_mfma_f32_16x16x32_bf16 v[144:147], v[16:19], v[48:51], v[144:147]
 ds_read_b128 v[76:79], v2 offset:32768
 ds_read_b32 v60, v60 offset:36864
 v_mfma_f32_16x16x32_bf16 v[148:151], v[16:19], v[52:55], v[148:151]
 v_lshrrev_b32 v62, 16, v14
 v_mfma_f32_16x16x32_bf16 v[152:155], v[20:23], v[48:51], v[152:155]
 ds_read_b128 v[80:83], v2 offset:34816
 ds_read_b32 v61, v61 offset:36864
 v_mfma_f32_16x16x32_bf16 v[156:159], v[20:23], v[52:55], v[156:159]
 v_lshrrev_b32 v63, 16, v15
 s_waitcnt lgkmcnt(14)
 v_mfma_f32_16x16x32_bf16 v[160:163], v[24:27], v[48:51], v[160:163]
 ds_read_b128 v[16:19], v0
 v_xor_b32 v0, 2112, v0
 ds_read_b32 v62, v62 offset:36864
 v_mfma_f32_16x16x32_bf16 v[164:167], v[24:27], v[52:55], v[164:167]
 ds_read_b32 v63, v63 offset:36864
 v_mfma_f32_16x16x32_bf16 v[168:171], v[28:31], v[48:51], v[168:171]
 ds_read_b128 v[20:23], v3 offset:0
 ds_read_b128 v[24:27], v3 offset:2048
 v_mfma_f32_16x16x32_bf16 v[172:175], v[28:31], v[52:55], v[172:175]
 s_waitcnt lgkmcnt(14)
 v_mfma_f32_16x16x32_bf16 v[176:179], v[32:35], v[48:51], v[176:179]
 ds_read_b128 v[28:31], v3 offset:4096
 v_mfma_f32_16x16x32_bf16 v[180:183], v[32:35], v[52:55], v[180:183]
 v_mfma_f32_16x16x32_bf16 v[184:187], v[36:39], v[48:51], v[184:187]
 ds_read_b128 v[32:35], v3 offset:6144
 v_mfma_f32_16x16x32_bf16 v[188:191], v[36:39], v[52:55], v[188:191]
 s_waitcnt lgkmcnt(14)
 v_mfma_f32_16x16x32_bf16 v[192:195], v[40:43], v[48:51], v[192:195]
 ds_read_b128 v[36:39], v3 offset:8192
 v_mfma_f32_16x16x32_bf16 v[196:199], v[40:43], v[52:55], v[196:199]
 v_mfma_f32_16x16x32_bf16 v[200:203], v[44:47], v[48:51], v[200:203]
 ds_read_b128 v[40:43], v3 offset:10240
 v_mfma_f32_16x16x32_bf16 v[204:207], v[44:47], v[52:55], v[204:207]
 s_waitcnt lgkmcnt(14)
 v_mfma_f32_16x16x32_bf16 v[208:211], v[64:67], v[48:51], v[208:211]
 ds_read_b128 v[44:47], v3 offset:12288
 v_mfma_f32_16x16x32_bf16 v[212:215], v[64:67], v[52:55], v[212:215]
 ds_read_b128 v[8:11], v4 offset:0
 ds_read_b128 v[12:15], v4 offset:4096
 v_mfma_f32_16x16x32_bf16 v[216:219], v[68:71], v[48:51], v[216:219]
 ds_read_b128 v[64:67], v3 offset:14336
 v_mfma_f32_16x16x32_bf16 v[220:223], v[68:71], v[52:55], v[220:223]
 v_add_u32 v4, s39, v4
 s_sub_u32 s39, 0, s39
 s_waitcnt lgkmcnt(14)
 v_mfma_f32_16x16x32_bf16 v[224:227], v[72:75], v[48:51], v[224:227]
 ds_read_b128 v[68:71], v3 offset:16384
 v_mfma_f32_16x16x32_bf16 v[228:231], v[72:75], v[52:55], v[228:231]
 v_mfma_f32_16x16x32_bf16 v[232:235], v[76:79], v[48:51], v[232:235]
 ds_read_b128 v[72:75], v3 offset:18432
 v_mfma_f32_16x16x32_bf16 v[236:239], v[76:79], v[52:55], v[236:239]
 s_waitcnt lgkmcnt(14)
 v_mfma_f32_16x16x32_bf16 v[240:243], v[80:83], v[48:51], v[240:243]
 ds_read_b128 v[76:79], v3 offset:20480
 v_mfma_f32_16x16x32_bf16 v[244:247], v[80:83], v[52:55], v[244:247]
 v_mfma_f32_16x16x32_bf16 v[248:251], v[16:19], v[56:59], v[248:251]
 ds_read_b128 v[80:83], v3 offset:22528
 s_waitcnt lgkmcnt(13)
 v_mfma_f32_16x16x32_bf16 v[252:255], v[16:19], v[60:63], v[252:255]
 v_mfma_f32_16x16x32_bf16 v[104:107], v[20:23], v[56:59], v[104:107]
 ds_read_b128 v[16:19], v3 offset:24576
 s_waitcnt lgkmcnt(7)
 v_and_b32 v48, s43, v8
 v_mfma_f32_16x16x32_bf16 v[108:111], v[20:23], v[60:63], v[108:111]
 v_and_b32 v49, s43, v9
 v_mfma_f32_16x16x32_bf16 v[112:115], v[24:27], v[56:59], v[112:115]
 ds_read_b128 v[20:23], v3 offset:26624
 ds_read_b32 v48, v48 offset:36864
 v_mfma_f32_16x16x32_bf16 v[116:119], v[24:27], v[60:63], v[116:119]
 v_and_b32 v50, s43, v10
 v_mfma_f32_16x16x32_bf16 v[120:123], v[28:31], v[56:59], v[120:123]
 ds_read_b128 v[24:27], v3 offset:28672
 ds_read_b32 v49, v49 offset:36864
 v_mfma_f32_16x16x32_bf16 v[124:127], v[28:31], v[60:63], v[124:127]
 v_and_b32 v51, s43, v11
 v_mfma_f32_16x16x32_bf16 v[128:131], v[32:35], v[56:59], v[128:131]
 ds_read_b128 v[28:31], v3 offset:30720
 ds_read_b32 v50, v50 offset:36864
 v_mfma_f32_16x16x32_bf16 v[132:135], v[32:35], v[60:63], v[132:135]
 v_lshrrev_b32 v52, 16, v8
 v_mfma_f32_16x16x32_bf16 v[136:139], v[36:39], v[56:59], v[136:139]
 ds_read_b128 v[32:35], v3 offset:32768
 ds_read_b32 v51, v51 offset:36864
 v_mfma_f32_16x16x32_bf16 v[140:143], v[36:39], v[60:63], v[140:143]
 v_lshrrev_b32 v53, 16, v9
 v_mfma_f32_16x16x32_bf16 v[144:147], v[40:43], v[56:59], v[144:147]
 ds_read_b128 v[36:39], v3 offset:34816
 ds_read_b32 v52, v52 offset:36864
 v_mfma_f32_16x16x32_bf16 v[148:151], v[40:43], v[60:63], v[148:151]
 v_lshrrev_b32 v54, 16, v10
 v_mfma_f32_16x16x32_bf16 v[152:155], v[44:47], v[56:59], v[152:155]
 ds_read_b32 v53, v53 offset:36864
 v_mfma_f32_16x16x32_bf16 v[156:159], v[44:47], v[60:63], v[156:159]
 v_lshrrev_b32 v55, 16, v11
 s_waitcnt lgkmcnt(14)
 v_mfma_f32_16x16x32_bf16 v[160:163], v[64:67], v[56:59], v[160:163]
 ds_read_b32 v54, v54 offset:36864
 v_mfma_f32_16x16x32_bf16 v[164:167], v[64:67], v[60:63], v[164:167]
 ds_read_b32 v55, v55 offset:36864
 v_mfma_f32_16x16x32_bf16 v[168:171], v[68:71], v[56:59], v[168:171]
 v_mfma_f32_16x16x32_bf16 v[172:175], v[68:71], v[60:63], v[172:175]
 s_waitcnt lgkmcnt(14)
 v_mfma_f32_16x16x32_bf16 v[176:179], v[72:75], v[56:59], v[176:179]
 v_mfma_f32_16x16x32_bf16 v[180:183], v[72:75], v[60:63], v[180:183]
 s_mov_b32 s44, s40
 s_mov_b32 s40, s41
 s_mov_b32 s41, s42
 s_mov_b32 s42, s44
 v_mfma_f32_16x16x32_bf16 v[184:187], v[76:79], v[56:59], v[184:187]
 s_sub_u32 s34, s34, 1
 s_cmp_lg_u32 s34, 0
 v_mfma_f32_16x16x32_bf16 v[188:191], v[76:79], v[60:63], v[188:191]
 s_waitcnt lgkmcnt(14)
 v_mfma_f32_16x16x32_bf16 v[192:195], v[80:83], v[56:59], v[192:195]
 v_add_u32 v2, s44, v2
 v_add_u32 v3, s44, v3
 v_mfma_f32_16x16x32_bf16 v[196:199], v[80:83], v[60:63], v[196:199]
 s_waitcnt lgkmcnt(0)
 s_barrier
 v_mfma_f32_16x16x32_bf16 v[200:203], v[16:19], v[56:59], v[200:203]
 s_cbranch_scc1 L_k19_t
 s_branch L_fin
L_k18:
 s_barrier
L_k18_t:
 v_mfma_f32_16x16x32_bf16 v[204:207], v[16:19], v[60:63], v[204:207]
 ds_read_b128 v[40:43], v2 offset:0
 v_mfma_f32_16x16x32_bf16 v[208:211], v[20:23], v[56:59], v[208:211]
 ds_read_b128 v[44:47], v2 offset:2048
 ds_read_b128 v[64:67], v2 offset:4096
 v_mfma_f32_16x16x32_bf16 v[212:215], v[20:23], v[60:63], v[212:215]
 ds_read_b128 v[68:71], v2 offset:6144
 v_mfma_f32_16x16x32_bf16 v[216:219], v[24:27], v[56:59], v[216:219]
 ds_read_b128 v[72:75], v2 offset:8192
 ds_read_b128 v[76:79], v2 offset:10240
 v_mfma_f32_16x16x32_bf16 v[220:223], v[24:27], v[60:63], v[220:223]
 ds_read_b128 v[16:19], v2 offset:12288
 v_mfma_f32_16x16x32_bf16 v[224:227], v[28:31], v[56:59], v[224:227]
 ds_read_b128 v[20:23], v2 offset:14336
 ds_read_b128 v[24:27], v2 offset:16384
 v_mfma_f32_16x16x32_bf16 v[228:231], v[28:31], v[60:63], v[228:231]
 v_mfma_f32_16x16x32_bf16 v[232:235], v[32:35], v[56:59], v[232:235]
 ds_read_b128 v[28:31], v2 offset:18432
 v_mfma_f32_16x16x32_bf16 v[236:239], v[32:35], v[60:63], v[236:239]
 v_mfma_f32_16x16x32_bf16 v[240:243], v[36:39], v[56:59], v[240:243]
 ds_read_b128 v[32:35], v2 offset:20480
 v_mfma_f32_16x16x32_bf16 v[244:247], v[36:39], v[60:63], v[244:247]
 s_waitcnt lgkmcnt(9)
 v_mfma_f32_16x16x32_bf16 v[104:107], v[40:43], v[48:51], v[104:107]
 ds_read_b128 v[36:39], v2 offset:22528
 v_mfma_f32_16x16x32_bf16 v[108:111], v[40:43], v[52:55], v[108:111]
 v_mfma_f32_16x16x32_bf16 v[112:115], v[44:47], v[48:51], v[112:115]
 ds_read_b128 v[40:43], v2 offset:24576
 v_and_b32 v56, s43, v12
 v_mfma_f32_16x16x32_bf16 v[116:119], v[44:47], v[52:55], v[116:119]
 v_and_b32 v57, s43, v13
 s_waitcnt lgkmcnt(9)
 v_mfma_f32_16x16x32_bf16 v[120:123], v[64:67], v[48:51], v[120:123]
 ds_read_b128 v[44:47], v2 offset:26624
 ds_read_b32 v56, v56 offset:36864
 v_mfma_f32_16x16x32_bf16 v[124:127], v[64:67], v[52:55], v[124:127]
 v_and_b32 v58, s43, v14
 v_mfma_f32_16x16x32_bf16 v[128:131], v[68:71], v[48:51], v[128:131]
 ds_read_b128 v[64:67], v2 offset:28672
 ds_read_b32 v57, v57 offset:36864
 v_mfma_f32_16x16x32_bf16 v[132:135], v[68:71], v[52:55], v[132:135]
 v_and_b32 v59, s43, v15
 s_waitcnt lgkmcnt(11)
 v_mfma_f32_16x16x32_bf16 v[136:139], v[72:75], v[48:51], v[136:139]
 ds_read_b128 v[68:71], v2 offset:30720
 ds_read_b32 v58, v58 offset:36864
 v_mfma_f32_16x16x32_bf16 v[140:143], v[72:75], v[52:55], v[140:143]
 v_lshrrev_b32 v60, 16, v12
 v_mfma_f32_16x16x32_bf16 v[144:147], v[76:79], v[48:51], v[144:147]
 ds_read_b128 v[72:75], v2 offset:32768
 ds_read_b32 v59, v59 offset:36864
 v_mfma_f32_16x16x32_bf16 v[148:151], v[76:79], v[52:55], v[148:151]
 v_lshrrev_b32 v61, 16, v13
 s_waitcnt lgkmcnt(13)
 v_mfma_f32_16x16x32_bf16 v[152:155], v[16:19], v[48:51], v[152:155]
 ds_read_b128 v[76:79], v2 offset:34816
 ds_read_b32 v60, v60 offset:36864
 v_mfma_f32_16x16x32_bf16 v[156:159], v[16:19], v[52:55], v[156:159]
 v_lshrrev_b32 v62, 16, v14
 v_mfma_f32_16x16x32_bf16 v[160:163], v[20:23], v[48:51], v[160:163]
 ds_read_b128 v[16:19], v3 offset:0
 ds_read_b32 v61, v61 offset:36864
 v_mfma_f32_16x16x32_bf16 v[164:167], v[20:23], v[52:55], v[164:167]
 v_lshrrev_b32 v63, 16, v15
 s_waitcnt lgkmcnt(14)
 v_mfma_f32_16x16x32_bf16 v[168:171], v[24:27], v[48:51], v[168:171]
 ds_read_b128 v[20:23], v3 offset:2048
 ds_read_b32 v62, v62 offset:36864
 v_mfma_f32_16x16x32_bf16 v[172:175], v[24:27], v[52:55], v[172:175]
 ds_read_b32 v63, v63 offset:36864
 v_mfma_f32_16x16x32_bf16 v[176:179], v[28:31], v[48:51], v[176:179]
 ds_read_b128 v[24:27], v3 offset:4096
 v_mfma_f32_16x16x32_bf16 v[180:183], v[28:31], v[52:55], v[180:183]
 s_waitcnt lgkmcnt(14)
 v_mfma_f32_16x16x32_bf16 v[184:187], v[32:35], v[48:51], v[184:187]
 ds_read_b128 v[28:31], v3 offset:6144
 v_mfma_f32_16x16x32_bf16 v[188:191], v[32:35], v[52:55], v[188:191]
 v_mfma_f32_16x16x32_bf16 v[192:195], v[36:39], v[48:51], v[192:195]
 ds_read_b128 v[32:35], v3 offset:8192
 v_mfma_f32_16x16x32_bf16 v[196:199], v[36:39], v[52:55], v[196:199]
 s_waitcnt lgkmcnt(14)
 v_mfma_f32_16x16x32_bf16 v[200:203], v[40:43], v[48:51], v[200:203]
 ds_read_b128 v[36:39], v3 offset:10240
 v_mfma_f32_16x16x32_bf16 v[204:207], v[40:43], v[52:55], v[204:207]
 v_mfma_f32_16x16x32_bf16 v[208:211], v[44:47], v[48:51], v[208:211]
 ds_read_b128 v[40:43], v3 offset:12288
 v_mfma_f32_16x16x32_bf16 v[212:215], v[44:47], v[52:55], v[212:215]
 ds_read_b128 v[8:11], v4 offset:0
 ds_read_b128 v[12:15], v4 offset:4096
 s_waitcnt lgkmcnt(14)
 v_mfma_f32_16x16x32_bf16 v[216:219], v[64:67], v[48:51], v[216:219]
 ds_read_b128 v[44:47], v3 offset:14336
 v_mfma_f32_16x16x32_bf16 v[220:223], v[64:67], v[52:55], v[220:223]
 v_add_u32 v4, s39, v4
 s_sub_u32 s39, 0, s39
 v_mfma_f32_16x16x32_bf16 v[224:227], v[68:71], v[48:51], v[224:227]
 ds_read_b128 v[64:67], v3 offset:16384
 v_mfma_f32_16x16x32_bf16 v[228:231], v[68:71], v[52:55], v[228:231]
 s_waitcnt lgkmcnt(14)
 v_mfma_f32_16x16x32_bf16 v[232:235], v[72:75], v[48:51], v[232:235]
 ds_read_b128 v[68:71], v3 offset:18432
 v_mfma_f32_16x16x32_bf16 v[236:239], v[72:75], v[52:55], v[236:239]
 v_mfma_f32_16x16x32_bf16 v[240:243], v[76:79], v[48:51], v[240:243]
 ds_read_b128 v[72:75], v3 offset:20480
 v_mfma_f32_16x16x32_bf16 v[244:247], v[76:79], v[52:55], v[244:247]
 s_waitcnt lgkmcnt(13)
 v_mfma_f32_16x16x32_bf16 v[104:107], v[16:19], v[56:59], v[104:107]
 ds_read_b128 v[76:79], v3 offset:22528
 s_waitcnt lgkmcnt(12)
 v_mfma_f32_16x16x32_bf16 v[108:111], v[16:19], v[60:63], v[108:111]
 v_mfma_f32_16x16x32_bf16 v[112:115], v[20:23], v[56:59], v[112:115]
 ds_read_b128 v[16:19], v3 offset:24576
 s_waitcnt lgkmcnt(7)
 v_and_b32 v48, s43, v8
 v_mfma_f32_16x16x32_bf16 v[116:119], v[20:23], v[60:63], v[116:119]
 v_and_b32 v49, s43, v9
 v_mfma_f32_16x16x32_bf16 v[120:123], v[24:27], v[56:59], v[120:123]
 ds_read_b128 v[20:23], v3 offset:26624
 ds_read_b32 v48, v48 offset:36864
 v_mfma_f32_16x16x32_bf16 v[124:127], v[24:27], v[60:63], v[124:127]
 v_and_b32 v50, s43, v10
 v_mfma_f32_16x16x32_bf16 v[128:131], v[28:31], v[56:59], v[128:131]
 ds_read_b128 v[24:27], v3 offset:28672
 ds_read_b32 v49, v49 offset:36864
 v_mfma_f32_16x16x32_bf16 v[132:135], v[28:31], v[60:63], v[132:135]
 v_and_b32 v51, s43, v11
 v_mfma_f32_16x16x32_bf16 v[136:139], v[32:35], v[56:59], v[136:139]
 ds_read_b128 v[28:31], v3 offset:30720
 ds_read_b32 v50, v50 offset:36864
 v_mfma_f32_16x16x32_bf16 v[140:143], v[32:35], v[60:63], v[140:143]
 v_lshrrev_b32 v52, 16, v8
 v_mfma_f32_16x16x32_bf16 v[144:147], v[36:39], v[56:59], v[144:147]
 ds_read_b128 v[32:35], v3 offset:32768
 ds_read_b32 v51, v51 offset:36864
 v_mfma_f32_16x16x32_bf16 v[148:151], v[36:39], v[60:63], v[148:151]
 v_lshrrev_b32 v53, 16, v9
 v_mfma_f32_16x16x32_bf16 v[152:155], v[40:43], v[56:59], v[152:155]
 ds_read_b128 v[36:39], v3 offset:34816
 ds_read_b32 v52, v52 offset:36864
 v_mfma_f32_16x16x32_bf16 v[156:159], v[40:43], v[60:63], v[156:159]
 v_lshrrev_b32 v54, 16, v10
 s_waitcnt lgkmcnt(14)
 v_mfma_f32_16x16x32_bf16 v[160:163], v[44:47], v[56:59], v[160:163]
 ds_read_b32 v53, v53 offset:36864
 v_mfma_f32_16x16x32_bf16 v[164:167], v[44:47], v[60:63], v[164:167]
 v_lshrrev_b32 v55, 16, v11
 v_mfma_f32_16x16x32_bf16 v[168:171], v[64:67], v[56:59], v[168:171]
 ds_read_b32 v54, v54 offset:36864
 v_mfma_f32_16x16x32_bf16 v[172:175], v[64:67], v[60:63], v[172:175]
 ds_read_b32 v55, v55 offset:36864
 s_waitcnt lgkmcnt(14)
 v_mfma_f32_16x16x32_bf16 v[176:179], v[68:71], v[56:59], v[176:179]
 v_mfma_f32_16x16x32_bf16 v[180:183], v[68:71], v[60:63], v[180:183]
 s_mov_b32 s44, s40
 s_mov_b32 s40, s41
 s_mov_b32 s41, s42
 s_mov_b32 s42, s44
 v_mfma_f32_16x16x32_bf16 v[184:187], v[72:75], v[56:59], v[184:187]
 s_sub_u32 s34, s34, 1
 s_cmp_lg_u32 s34, 0
 v_mfma_f32_16x16x32_bf16 v[188:191], v[72:75], v[60:63], v[188:191]
 s_waitcnt lgkmcnt(14)
 v_mfma_f32_16x16x32_bf16 v[192:195], v[76:79], v[56:59], v[192:195]
 v_add_u32 v2, s44, v2
 v_add_u32 v3, s44, v3
 v_mfma_f32_16x16x32_bf16 v[196:199], v[76:79], v[60:63], v[196:199]
 s_waitcnt lgkmcnt(0)
 s_barrier
 v_mfma_f32_16x16x32_bf16 v[200:203], v[16:19], v[56:59], v[200:203]
 s_cbranch_scc1 L_k18_t
L_fin:
L_dry0:
 s_waitcnt vmcnt(0)
 v_lshlrev_b32 v5, 16, v6
 v_and_b32 v6, 0xffff0000, v6
 v_add_u32 v8, 86016, v2
 v_add_u32 v9, 86016, v3
 ds_read_b128 v[76:79], v4 offset:0
 ds_read_b128 v[84:87], v4 offset:4096
 v_add_u32 v4, s39, v4
 ds_read_b128 v[40:43], v2 offset:0
 ds_read_b128 v[44:47], v2 offset:2048
 v_and_b32 v64, s43, v12
 v_mfma_f32_16x16x32_bf16 v[204:207], v[16:19], v[60:63], v[204:207]
 v_and_b32 v65, s43, v13
 ds_read_b32 v64, v64 offset:36864
 v_mfma_f32_16x16x32_bf16 v[208:211], v[20:23], v[56:59], v[208:211]
 ds_read_b128 v[16:19], v2 offset:4096
 v_and_b32 v66, s43, v14
 v_mfma_f32_16x16x32_bf16 v[212:215], v[20:23], v[60:63], v[212:215]
 ds_read_b32 v65, v65 offset:36864
 v_and_b32 v67, s43, v15
 v_mfma_f32_16x16x32_bf16 v[216:219], v[24:27], v[56:59], v[216:219]
 ds_read_b128 v[20:23], v2 offset:6144
 ds_read_b32 v66, v66 offset:36864
 v_mfma_f32_16x16x32_bf16 v[220:223], v[24:27], v[60:63], v[220:223]
 v_lshrrev_b32 v68, 16, v12
 ds_read_b32 v67, v67 offset:36864
 v_mfma_f32_16x16x32_bf16 v[224:227], v[28:31], v[56:59], v[224:227]
 ds_read_b128 v[24:27], v2 offset:8192
 v_lshrrev_b32 v69, 16, v13
 v_mfma_f32_16x16x32_bf16 v[228:231], v[28:31], v[60:63], v[228:231]
 ds_read_b32 v68, v68 offset:36864
 v_lshrrev_b32 v70, 16, v14
 v_mfma_f32_16x16x32_bf16 v[232:235], v[32:35], v[56:59], v[232:235]
 ds_read_b128 v[28:31], v3 offset:0
 ds_read_b32 v69, v69 offset:36864
 v_mfma_f32_16x16x32_bf16 v[236:239], v[32:35], v[60:63], v[236:239]
 v_lshrrev_b32 v71, 16, v15
 ds_read_b32 v70, v70 offset:36864
 v_mfma_f32_16x16x32_bf16 v[240:243], v[36:39], v[56:59], v[240:243]
 ds_read_b128 v[32:35], v3 offset:2048
 s_waitcnt lgkmcnt(14)
 v_and_b32 v72, s43, v76
 v_mfma_f32_16x16x32_bf16 v[244:247], v[36:39], v[60:63], v[244:247]
 ds_read_b32 v71, v71 offset:36864
 v_and_b32 v73, s43, v77
 s_waitcnt lgkmcnt(13)
 v_mfma_f32_16x16x32_bf16 v[104:107], v[40:43], v[48:51], v[104:107]
 ds_read_b128 v[36:39], v3 offset:4096
 ds_read_b32 v72, v72 offset:36864
 v_mfma_f32_16x16x32_bf16 v[108:111], v[40:43], v[52:55], v[108:111]
 v_and_b32 v74, s43, v78
 ds_read_b32 v73, v73 offset:36864
 v_mfma_f32_16x16x32_bf16 v[112:115], v[44:47], v[48:51], v[112:115]
 ds_read_b128 v[40:43], v3 offset:6144
 v_and_b32 v75, s43, v79
 v_mfma_f32_16x16x32_bf16 v[116:119], v[44:47], v[52:55], v[116:119]
 ds_read_b32 v74, v74 offset:36864
 v_lshrrev_b32 v76, 16, v76
 s_waitcnt lgkmcnt(14)
 v_mfma_f32_16x16x32_bf16 v[120:123], v[16:19], v[48:51], v[120:123]
 ds_read_b128 v[44:47], v3 offset:8192
 ds_read_b32 v75, v75 offset:36864
 v_mfma_f32_16x16x32_bf16 v[124:127], v[16:19], v[52:55], v[124:127]
 v_lshrrev_b32 v77, 16, v77
 ds_read_b32 v76, v76 offset:36864
 v_mfma_f32_16x16x32_bf16 v[128:131], v[20:23], v[48:51], v[128:131]
 s_cbranch_execz L_sk1
 s_barrier
L_sk1:
 ds_read_b128 v[92:95], v4 offset:0
 ds_read_b128 v[100:103], v4 offset:4096
 ds_read_b128 v[16:19], v8 offset:0
 v_lshrrev_b32 v78, 16, v78
 v_mfma_f32_16x16x32_bf16 v[132:135], v[20:23], v[52:55], v[132:135]
 ds_read_b32 v77, v77 offset:36864
 v_lshrrev_b32 v79, 16, v79
 s_waitcnt lgkmcnt(14)
 v_mfma_f32_16x16x32_bf16 v[136:139], v[24:27], v[48:51], v[136:139]
 ds_read_b128 v[20:23], v8 offset:2048
 ds_read_b32 v78, v78 offset:36864
 v_mfma_f32_16x16x32_bf16 v[140:143], v[24:27], v[52:55], v[140:143]
 v_and_b32 v80, s43, v84
 ds_read_b32 v79, v79 offset:36864
 v_mfma_f32_16x16x32_bf16 v[104:107], v[28:31], v[64:67], v[104:107]
 ds_read_b128 v[24:27], v8 offset:4096
 v_and_b32 v81, s43, v85
 s_waitcnt lgkmcnt(14)
 v_mfma_f32_16x16x32_bf16 v[108:111], v[28:31], v[68:71], v[108:111]
 ds_read_b32 v80, v80 offset:36864
 v_and_b32 v82, s43, v86
 v_mfma_f32_16x16x32_bf16 v[112:115], v[32:35], v[64:67], v[112:115]
 ds_read_b128 v[28:31], v8 offset:6144
 ds_read_b32 v81, v81 offset:36864
 v_mfma_f32_16x16x32_bf16 v[116:119], v[32:35], v[68:71], v[116:119]
 v_and_b32 v83, s43, v87
 ds_read_b32 v82, v82 offset:36864
 s_waitcnt lgkmcnt(14)
 v_mfma_f32_16x16x32_bf16 v[120:123], v[36:39], v[64:67], v[120:123]
 ds_read_b128 v[32:35], v8 offset:8192
 v_lshrrev_b32 v84, 16, v84
 v_mfma_f32_16x16x32_bf16 v[124:127], v[36:39], v[68:71], v[124:127]
 ds_read_b32 v83, v83 offset:36864
 v_lshrrev_b32 v85, 16, v85
 v_mfma_f32_16x16x32_bf16 v[128:131], v[40:43], v[64:67], v[128:131]
 ds_read_b128 v[36:39], v9 offset:0
 ds_read_b32 v84, v84 offset:36864
 v_mfma_f32_16x16x32_bf16 v[132:135], v[40:43], v[68:71], v[132:135]
 v_lshrrev_b32 v86, 16, v86
 ds_read_b32 v85, v85 offset:36864
 s_waitcnt lgkmcnt(14)
 v_mfma_f32_16x16x32_bf16 v[136:139], v[44:47], v[64:67], v[136:139]
 ds_read_b128 v[40:43], v9 offset:2048
 v_lshrrev_b32 v87, 16, v87
 v_mfma_f32_16x16x32_bf16 v[140:143], v[44:47], v[68:71], v[140:143]
 ds_read_b32 v86, v86 offset:36864
 v_and_b32 v88, s43, v92
 v_mfma_f32_16x16x32_bf16 v[104:107], v[16:19], v[72:75], v[104:107]
 ds_read_b128 v[44:47], v9 offset:4096
 ds_read_b32 v87, v87 offset:36864
 s_waitcnt lgkmcnt(14)
 v_mfma_f32_16x16x32_bf16 v[108:111], v[16:19], v[76:79], v[108:111]
 v_and_b32 v89, s43, v93
 ds_read_b32 v88, v88 offset:36864
 v_mfma_f32_16x16x32_bf16 v[112:115], v[20:23], v[72:75], v[112:115]
 ds_read_b128 v[16:19], v9 offset:6144
 v_and_b32 v90, s43, v94
 v_mfma_f32_16x16x32_bf16 v[116:119], v[20:23], v[76:79], v[116:119]
 ds_read_b32 v89, v89 offset:36864
 v_and_b32 v91, s43, v95
 s_waitcnt lgkmcnt(14)
 v_mfma_f32_16x16x32_bf16 v[120:123], v[24:27], v[72:75], v[120:123]
 ds_read_b128 v[20:23], v9 offset:8192
 ds_read_b32 v90, v90 offset:36864
 v_mfma_f32_16x16x32_bf16 v[124:127], v[24:27], v[76:79], v[124:127]
 v_lshrrev_b32 v92, 16, v92
 ds_read_b32 v91, v91 offset:36864
 v_mfma_f32_16x16x32_bf16 v[128:131], v[28:31], v[72:75], v[128:131]
 s_cbranch_execz L_sk2
 s_barrier
L_sk2:
 ds_read_b128 v[24:27], v8 offset:36864
 v_lshrrev_b32 v93, 16, v93
 v_mfma_f32_16x16x32_bf16 v[132:135], v[28:31], v[76:79], v[132:135]
 ds_read_b32 v92, v92 offset:36864
 v_lshrrev_b32 v94, 16, v94
 s_waitcnt lgkmcnt(14)
 v_mfma_f32_16x16x32_bf16 v[136:139], v[32:35], v[72:75], v[136:139]
 ds_read_b128 v[28:31], v9 offset:36864
 ds_read_b32 v93, v93 offset:36864
 v_mfma_f32_16x16x32_bf16 v[140:143], v[32:35], v[76:79], v[140:143]
 v_lshrrev_b32 v95, 16, v95
 ds_read_b32 v94, v94 offset:36864
 v_mfma_f32_16x16x32_bf16 v[104:107], v[36:39], v[80:83], v[104:107]
 ds_read_b128 v[32:35], v8 offset:38912
 v_and_b32 v96, s43, v100
 s_waitcnt lgkmcnt(12)
 v_mfma_f32_16x16x32_bf16 v[108:111], v[36:39], v[84:87], v[108:111]
 ds_read_b32 v95, v95 offset:36864
 v_and_b32 v97, s43, v101
 v_mfma_f32_16x16x32_bf16 v[112:115], v[40:43], v[80:83], v[112:115]
 ds_read_b128 v[36:39], v9 offset:38912
 ds_read_b32 v96, v96 offset:36864
 v_mfma_f32_16x16x32_bf16 v[116:119], v[40:43], v[84:87], v[116:119]
 v_and_b32 v98, s43, v102
 ds_read_b32 v97, v97 offset:36864
 v_mfma_f32_16x16x32_bf16 v[120:123], v[44:47], v[80:83], v[120:123]
 ds_read_b128 v[40:43], v8 offset:40960
 v_and_b32 v99, s43, v103
 v_mfma_f32_16x16x32_bf16 v[124:127], v[44:47], v[84:87], v[124:127]
 ds_read_b32 v98, v98 offset:36864
 v_lshrrev_b32 v100, 16, v100
 s_waitcnt lgkmcnt(14)
 v_mfma_f32_16x16x32_bf16 v[128:131], v[16:19], v[80:83], v[128:131]
 ds_read_b128 v[44:47], v9 offset:40960
 ds_read_b32 v99, v99 offset:36864
 v_mfma_f32_16x16x32_bf16 v[132:135], v[16:19], v[84:87], v[132:135]
 v_lshrrev_b32 v101, 16, v101
 ds_read_b32 v100, v100 offset:36864
 v_mfma_f32_16x16x32_bf16 v[136:139], v[20:23], v[80:83], v[136:139]
 ds_read_b128 v[16:19], v8 offset:43008
 v_lshrrev_b32 v102, 16, v102
 v_mfma_f32_16x16x32_bf16 v[140:143], v[20:23], v[84:87], v[140:143]
 ds_read_b32 v101, v101 offset:36864
 v_lshrrev_b32 v103, 16, v103
 s_waitcnt lgkmcnt(14)
 v_mfma_f32_16x16x32_bf16 v[104:107], v[24:27], v[88:91], v[104:107]
 ds_read_b128 v[20:23], v9 offset:43008
 ds_read_b32 v102, v102 offset:36864
 s_waitcnt lgkmcnt(12)
 v_mfma_f32_16x16x32_bf16 v[108:111], v[24:27], v[92:95], v[108:111]
 ds_read_b32 v103, v103 offset:36864
 s_waitcnt lgkmcnt(6)
 v_mfma_f32_16x16x32_bf16 v[104:107], v[28:31], v[96:99], v[104:107]
 ds_read_b128 v[24:27], v8 offset:45056
 s_waitcnt lgkmcnt(1)
 v_mfma_f32_16x16x32_bf16 v[108:111], v[28:31], v[100:103], v[108:111]
 v_mfma_f32_16x16x32_bf16 v[112:115], v[32:35], v[88:91], v[112:115]
 ds_read_b128 v[28:31], v9 offset:45056
 v_mfma_f32_16x16x32_bf16 v[116:119], v[32:35], v[92:95], v[116:119]
 v_mfma_f32_16x16x32_bf16 v[112:115], v[36:39], v[96:99], v[112:115]
 ds_read_b128 v[32:35], v2 offset:10240
 v_mfma_f32_16x16x32_bf16 v[116:119], v[36:39], v[100:103], v[116:119]
 v_mfma_f32_16x16x32_bf16 v[120:123], v[40:43], v[88:91], v[120:123]
 ds_read_b128 v[36:39], v3 offset:10240
 v_mul_f32 v104, v104, v5
 v_mul_f32 v108, v108, v6
 v_mul_f32 v105, v105, v5
 v_mfma_f32_16x16x32_bf16 v[124:127], v[40:43], v[92:95], v[124:127]
 v_mul_f32 v109, v109, v6
 v_cvt_pk_bf16_f32 v104, v104, v108
 v_mul_f32 v106, v106, v5
 v_mfma_f32_16x16x32_bf16 v[120:123], v[44:47], v[96:99], v[120:123]
 ds_read_b128 v[40:43], v8 offset:10240
 ds_write_addtid_b32 v104 offset:57344
 v_mul_f32 v110, v110, v6
 v_cvt_pk_bf16_f32 v105, v105, v109
 v_mul_f32 v107, v107, v5
 v_mfma_f32_16x16x32_bf16 v[124:127], v[44:47], v[100:103], v[124:127]
 ds_write_addtid_b32 v105 offset:57600
 v_mul_f32 v111, v111, v6
 v_cvt_pk_bf16_f32 v106, v106, v110
 v_cvt_pk_bf16_f32 v107, v107, v111
 v_mfma_f32_16x16x32_bf16 v[128:131], v[16:19], v[88:91], v[128:131]
 ds_read_b128 v[44:47], v9 offset:10240
 ds_write_addtid_b32 v106 offset:57856
 v_mul_f32 v112, v112, v5
 v_mfma_f32_16x16x32_bf16 v[132:135], v[16:19], v[92:95], v[132:135]
 ds_write_addtid_b32 v107 offset:58112
 v_mul_f32 v116, v116, v6
 v_mfma_f32_16x16x32_bf16 v[128:131], v[20:23], v[96:99], v[128:131]
 ds_read_b128 v[16:19], v8 offset:47104
 v_mul_f32 v113, v113, v5
 v_mfma_f32_16x16x32_bf16 v[132:135], v[20:23], v[100:103], v[132:135]
 v_mul_f32 v117, v117, v6
 s_waitcnt lgkmcnt(9)
 v_mfma_f32_16x16x32_bf16 v[136:139], v[24:27], v[88:91], v[136:139]
 ds_read_b128 v[20:23], v9 offset:47104
 v_cvt_pk_bf16_f32 v112, v112, v116
 v_mul_f32 v114, v114, v5
 v_mul_f32 v118, v118, v6
 v_mfma_f32_16x16x32_bf16 v[140:143], v[24:27], v[92:95], v[140:143]
 ds_write_addtid_b32 v112 offset:61440
 v_cvt_pk_bf16_f32 v113, v113, v117
 v_mul_f32 v115, v115, v5
 v_mul_f32 v119, v119, v6
 s_waitcnt lgkmcnt(3)
 s_cbranch_execz L_sk3
 s_barrier
L_sk3:
 v_mfma_f32_16x16x32_bf16 v[136:139], v[28:31], v[96:99], v[136:139]
 ds_read_b128 v[24:27], v2 offset:12288
 ds_write_addtid_b32 v113 offset:61696
 v_cvt_pk_bf16_f32 v114, v114, v118
 v_mfma_f32_16x16x32_bf16 v[140:143], v[28:31], v[100:103], v[140:143]
 ds_write_addtid_b32 v114 offset:61952
 v_cvt_pk_bf16_f32 v115, v115, v119
 v_mfma_f32_16x16x32_bf16 v[144:147], v[32:35], v[48:51], v[144:147]
 ds_read_b128 v[28:31], v3 offset:12288
 ds_write_addtid_b32 v115 offset:62208
 v_mul_f32 v120, v120, v5
 v_mul_f32 v124, v124, v6
 v_mul_f32 v121, v121, v5
 v_mfma_f32_16x16x32_bf16 v[148:151], v[32:35], v[52:55], v[148:151]
 v_mul_f32 v125, v125, v6
 v_cvt_pk_bf16_f32 v120, v120, v124
 v_mul_f32 v122, v122, v5
 v_mfma_f32_16x16x32_bf16 v[144:147], v[36:39], v[64:67], v[144:147]
 ds_read_b128 v[32:35], v8 offset:12288
 v_mul_f32 v126, v126, v6
 v_cvt_pk_bf16_f32 v121, v121, v125
 v_mul_f32 v123, v123, v5
 v_mfma_f32_16x16x32_bf16 v[148:151], v[36:39], v[68:71], v[148:151]
 ds_write_addtid_b32 v120 offset:16384
 v_mul_f32 v127, v127, v6
 v_cvt_pk_bf16_f32 v122, v122, v126
 v_cvt_pk_bf16_f32 v123, v123, v127
 v_mfma_f32_16x16x32_bf16 v[144:147], v[40:43], v[72:75], v[144:147]
 ds_read_b128 v[36:39], v9 offset:12288
 ds_write_addtid_b32 v121 offset:16640
 v_mul_f32 v128, v128, v5
 v_mul_f32 v132, v132, v6
 v_mul_f32 v129, v129, v5
 v_mfma_f32_16x16x32_bf16 v[148:151], v[40:43], v[76:79], v[148:151]
 ds_write_addtid_b32 v122 offset:16896
 v_mul_f32 v133, v133, v6
 v_cvt_pk_bf16_f32 v128, v128, v132
 v_mul_f32 v130, v130, v5
 s_waitcnt lgkmcnt(5)
 s_cbranch_execz L_sk4
 s_barrier
L_sk4:
 v_mfma_f32_16x16x32_bf16 v[144:147], v[44:47], v[80:83], v[144:147]
 ds_read_b128 v[40:43], v8 offset:49152
 ds_write_addtid_b32 v123 offset:17152
 v_mul_f32 v134, v134, v6
 v_cvt_pk_bf16_f32 v129, v129, v133
 v_mul_f32 v131, v131, v5
 v_mfma_f32_16x16x32_bf16 v[148:151], v[44:47], v[84:87], v[148:151]
 ds_write_addtid_b32 v128 offset:20480
 v_mul_f32 v135, v135, v6
 v_cvt_pk_bf16_f32 v130, v130, v134
 v_cvt_pk_bf16_f32 v131, v131, v135
 s_cbranch_execz L_dry_done
L_dry1:
 v_mfma_f32_16x16x32_bf16 v[144:147], v[16:19], v[88:91], v[144:147]
 ds_read_b128 v[44:47], v9 offset:49152
 ds_write_addtid_b32 v129 offset:20736
 v_mul_f32 v136, v136, v5
 v_mfma_f32_16x16x32_bf16 v[148:151], v[16:19], v[92:95], v[148:151]
 ds_write_addtid_b32 v130 offset:20992
 v_mul_f32 v140, v140, v6
 v_mfma_f32_16x16x32_bf16 v[144:147], v[20:23], v[96:99], v[144:147]
 ds_read_b128 v[16:19], v2 offset:14336
 ds_write_addtid_b32 v131 offset:21248
 v_mul_f32 v137, v137, v5
 v_mfma_f32_16x16x32_bf16 v[148:151], v[20:23], v[100:103], v[148:151]
 v_mul_f32 v141, v141, v6
 v_mfma_f32_16x16x32_bf16 v[152:155], v[24:27], v[48:51], v[152:155]
 ds_read_b128 v[20:23], v3 offset:14336
 v_cvt_pk_bf16_f32 v136, v136, v140
 v_mfma_f32_16x16x32_bf16 v[156:159], v[24:27], v[52:55], v[156:159]
 ds_write_addtid_b32 v136 offset:24576
 v_mul_f32 v138, v138, v5
 v_mfma_f32_16x16x32_bf16 v[152:155], v[28:31], v[64:67], v[152:155]
 ds_read_b128 v[24:27], v8 offset:14336
 v_mul_f32 v142, v142, v6
 v_mfma_f32_16x16x32_bf16 v[156:159], v[28:31], v[68:71], v[156:159]
 v_cvt_pk_bf16_f32 v137, v137, v141
 s_waitcnt lgkmcnt(3)
 s_cbranch_execz L_sk5
 s_barrier
L_sk5:
 v_mfma_f32_16x16x32_bf16 v[152:155], v[32:35], v[72:75], v[152:155]
 ds_read_b128 v[28:31], v9 offset:14336
 v_mul_f32 v139, v139, v5
 v_mul_f32 v143, v143, v6
 v_cvt_pk_bf16_f32 v138, v138, v142
 v_mfma_f32_16x16x32_bf16 v[156:159], v[32:35], v[76:79], v[156:159]
 ds_write_addtid_b32 v137 offset:24832
 v_cvt_pk_bf16_f32 v139, v139, v143
 v_mfma_f32_16x16x32_bf16 v[152:155], v[36:39], v[80:83], v[152:155]
 ds_read_b128 v[32:35], v8 offset:51200
 ds_write_addtid_b32 v138 offset:25088
 v_mul_f32 v144, v144, v5
 v_mfma_f32_16x16x32_bf16 v[156:159], v[36:39], v[84:87], v[156:159]
 ds_write_addtid_b32 v139 offset:25344
 v_mul_f32 v148, v148, v6
 v_mfma_f32_16x16x32_bf16 v[152:155], v[40:43], v[88:91], v[152:155]
 ds_read_b128 v[36:39], v9 offset:51200
 v_mul_f32 v145, v145, v5
 v_mfma_f32_16x16x32_bf16 v[156:159], v[40:43], v[92:95], v[156:159]
 v_mul_f32 v149, v149, v6
 v_mfma_f32_16x16x32_bf16 v[152:155], v[44:47], v[96:99], v[152:155]
 ds_read_b128 v[40:43], v2 offset:16384
 v_cvt_pk_bf16_f32 v144, v144, v148
 v_mfma_f32_16x16x32_bf16 v[156:159], v[44:47], v[100:103], v[156:159]
 ds_write_addtid_b32 v144 offset:28672
 v_mul_f32 v146, v146, v5
 v_mfma_f32_16x16x32_bf16 v[160:163], v[16:19], v[48:51], v[160:163]
 ds_read_b128 v[44:47], v3 offset:16384
 v_mul_f32 v150, v150, v6
 v_mfma_f32_16x16x32_bf16 v[164:167], v[16:19], v[52:55], v[164:167]
 v_cvt_pk_bf16_f32 v145, v145, v149
 s_waitcnt lgkmcnt(9)
 v_mfma_f32_16x16x32_bf16 v[160:163], v[20:23], v[64:67], v[160:163]
 ds_read_b128 v[16:19], v8 offset:16384
 v_mul_f32 v147, v147, v5
 v_mfma_f32_16x16x32_bf16 v[164:167], v[20:23], v[68:71], v[164:167]
 ds_write_addtid_b32 v145 offset:28928
 v_mul_f32 v151, v151, v6
 v_mfma_f32_16x16x32_bf16 v[160:163], v[24:27], v[72:75], v[160:163]
 ds_read_b128 v[20:23], v9 offset:16384
 v_cvt_pk_bf16_f32 v146, v146, v150
 v_mfma_f32_16x16x32_bf16 v[164:167], v[24:27], v[76:79], v[164:167]
 ds_write_addtid_b32 v146 offset:29184
 v_cvt_pk_bf16_f32 v147, v147, v151
 s_waitcnt lgkmcnt(10)
 v_mfma_f32_16x16x32_bf16 v[160:163], v[28:31], v[80:83], v[160:163]
 ds_read_b128 v[24:27], v8 offset:53248
 v_add_u32 v8, 18432, v8
 ds_write_addtid_b32 v147 offset:29440
 v_mul_f32 v152, v152, v5
 v_mfma_f32_16x16x32_bf16 v[164:167], v[28:31], v[84:87], v[164:167]
 v_mul_f32 v156, v156, v6
 v_mfma_f32_16x16x32_bf16 v[160:163], v[32:35], v[88:91], v[160:163]
 ds_read_b128 v[28:31], v9 offset:53248
 v_add_u32 v9, 18432, v9
 v_mul_f32 v153, v153, v5
 v_mfma_f32_16x16x32_bf16 v[164:167], v[32:35], v[92:95], v[164:167]
 v_mul_f32 v157, v157, v6
 s_waitcnt lgkmcnt(9)
 v_mfma_f32_16x16x32_bf16 v[160:163], v[36:39], v[96:99], v[160:163]
 ds_read_b128 v[32:35], v2 offset:18432
 v_cvt_pk_bf16_f32 v152, v152, v156
 v_mfma_f32_16x16x32_bf16 v[164:167], v[36:39], v[100:103], v[164:167]
 ds_write_addtid_b32 v152 offset:32768
 v_mul_f32 v154, v154, v5
 s_waitcnt lgkmcnt(3)
 s_cbranch_execz L_sk6
 s_barrier
L_sk6:
 v_mfma_f32_16x16x32_bf16 v[168:171], v[40:43], v[48:51], v[168:171]
 ds_read_b128 v[36:39], v3 offset:18432
 v_mul_f32 v158, v158, v6
 v_mfma_f32_16x16x32_bf16 v[172:175], v[40:43], v[52:55], v[172:175]
 v_cvt_pk_bf16_f32 v153, v153, v157
 v_mfma_f32_16x16x32_bf16 v[168:171], v[44:47], v[64:67], v[168:171]
 ds_read_b128 v[40:43], v8 offset:0
 v_mul_f32 v155, v155, v5
 v_mfma_f32_16x16x32_bf16 v[172:175], v[44:47], v[68:71], v[172:175]
 ds_write_addtid_b32 v153 offset:33024
 v_mul_f32 v159, v159, v6
 v_mfma_f32_16x16x32_bf16 v[168:171], v[16:19], v[72:75], v[168:171]
 ds_read_b128 v[44:47], v9 offset:0
 v_cvt_pk_bf16_f32 v154, v154, v158
 v_mfma_f32_16x16x32_bf16 v[172:175], v[16:19], v[76:79], v[172:175]
 ds_write_addtid_b32 v154 offset:33280
 v_cvt_pk_bf16_f32 v155, v155, v159
 v_mfma_f32_16x16x32_bf16 v[168:171], v[20:23], v[80:83], v[168:171]
 ds_read_b128 v[16:19], v8 offset:36864
 ds_write_addtid_b32 v155 offset:33536
 v_mul_f32 v160, v160, v5
 v_mfma_f32_16x16x32_bf16 v[172:175], v[20:23], v[84:87], v[172:175]
 v_mul_f32 v164, v164, v6
 v_mfma_f32_16x16x32_bf16 v[168:171], v[24:27], v[88:91], v[168:171]
 ds_read_b128 v[20:23], v9 offset:36864
 v_mul_f32 v161, v161, v5
 v_mfma_f32_16x16x32_bf16 v[172:175], v[24:27], v[92:95], v[172:175]
 v_mul_f32 v165, v165, v6
 s_waitcnt lgkmcnt(9)
 v_mfma_f32_16x16x32_bf16 v[168:171], v[28:31], v[96:99], v[168:171]
 ds_read_b128 v[24:27], v2 offset:20480
 v_cvt_pk_bf16_f32 v160, v160, v164
 v_mfma_f32_16x16x32_bf16 v[172:175], v[28:31], v[100:103], v[172:175]
 ds_write_addtid_b32 v160 offset:36864
 v_mul_f32 v162, v162, v5
 v_mfma_f32_16x16x32_bf16 v[176:179], v[32:35], v[48:51], v[176:179]
 ds_read_b128 v[28:31], v3 offset:20480
 v_mul_f32 v166, v166, v6
 v_mfma_f32_16x16x32_bf16 v[180:183], v[32:35], v[52:55], v[180:183]
 v_cvt_pk_bf16_f32 v161, v161, v165
 s_waitcnt lgkmcnt(9)
 v_mfma_f32_16x16x32_bf16 v[176:179], v[36:39], v[64:67], v[176:179]
 ds_read_b128 v[32:35], v8 offset:2048
 v_mul_f32 v163, v163, v5
 v_mfma_f32_16x16x32_bf16 v[180:183], v[36:39], v[68:71], v[180:183]
 ds_write_addtid_b32 v161 offset:37120
 v_mul_f32 v167, v167, v6
 v_mfma_f32_16x16x32_bf16 v[176:179], v[40:43], v[72:75], v[176:179]
 ds_read_b128 v[36:39], v9 offset:2048
 v_cvt_pk_bf16_f32 v162, v162, v166
 v_mfma_f32_16x16x32_bf16 v[180:183], v[40:43], v[76:79], v[180:183]
 ds_write_addtid_b32 v162 offset:37376
 v_cvt_pk_bf16_f32 v163, v163, v167
 s_waitcnt lgkmcnt(9)
 v_mfma_f32_16x16x32_bf16 v[176:179], v[44:47], v[80:83], v[176:179]
 ds_read_b128 v[40:43], v8 offset:38912
 ds_write_addtid_b32 v163 offset:37632
 v_mul_f32 v168, v168, v5
 v_mfma_f32_16x16x32_bf16 v[180:183], v[44:47], v[84:87], v[180:183]
 v_mul_f32 v172, v172, v6
 v_mfma_f32_16x16x32_bf16 v[176:179], v[16:19], v[88:91], v[176:179]
 ds_read_b128 v[44:47], v9 offset:38912
 v_mul_f32 v169, v169, v5
 v_mfma_f32_16x16x32_bf16 v[180:183], v[16:19], v[92:95], v[180:183]
 v_mul_f32 v173, v173, v6
 s_waitcnt lgkmcnt(9)
 v_mfma_f32_16x16x32_bf16 v[176:179], v[20:23], v[96:99], v[176:179]
 ds_read_b128 v[16:19], v2 offset:22528
 v_cvt_pk_bf16_f32 v168, v168, v172
 v_mfma_f32_16x16x32_bf16 v[180:183], v[20:23], v[100:103], v[180:183]
 ds_write_addtid_b32 v168 offset:40960
 v_mul_f32 v170, v170, v5
 s_waitcnt lgkmcnt(3)
 s_cbranch_execz L_sk7
 s_barrier
L_sk7:
 v_mfma_f32_16x16x32_bf16 v[184:187], v[24:27], v[48:51], v[184:187]
 ds_read_b128 v[20:23], v3 offset:22528
 v_mul_f32 v174, v174, v6
 v_mfma_f32_16x16x32_bf16 v[188:191], v[24:27], v[52:55], v[188:191]
 v_cvt_pk_bf16_f32 v169, v169, v173
 v_mfma_f32_16x16x32_bf16 v[184:187], v[28:31], v[64:67], v[184:187]
 ds_read_b128 v[24:27], v8 offset:4096
 v_mul_f32 v171, v171, v5
 v_mfma_f32_16x16x32_bf16 v[188:191], v[28:31], v[68:71], v[188:191]
 ds_write_addtid_b32 v169 offset:41216
 v_mul_f32 v175, v175, v6
 v_mfma_f32_16x16x32_bf16 v[184:187], v[32:35], v[72:75], v[184:187]
 ds_read_b128 v[28:31], v9 offset:4096
 v_cvt_pk_bf16_f32 v170, v170, v174
 v_mfma_f32_16x16x32_bf16 v[188:191], v[32:35], v[76:79], v[188:191]
 ds_write_addtid_b32 v170 offset:41472
 v_cvt_pk_bf16_f32 v171, v171, v175
 v_mfma_f32_16x16x32_bf16 v[184:187], v[36:39], v[80:83], v[184:187]
 ds_read_b128 v[32:35], v8 offset:40960
 ds_write_addtid_b32 v171 offset:41728
 v_mul_f32 v176, v176, v5
 v_mfma_f32_16x16x32_bf16 v[188:191], v[36:39], v[84:87], v[188:191]
 v_mul_f32 v180, v180, v6
 v_mfma_f32_16x16x32_bf16 v[184:187], v[40:43], v[88:91], v[184:187]
 ds_read_b128 v[36:39], v9 offset:40960
 v_mul_f32 v177, v177, v5
 v_mfma_f32_16x16x32_bf16 v[188:191], v[40:43], v[92:95], v[188:191]
 v_mul_f32 v181, v181, v6
 s_waitcnt lgkmcnt(9)
 v_mfma_f32_16x16x32_bf16 v[184:187], v[44:47], v[96:99], v[184:187]
 ds_read_b128 v[40:43], v2 offset:24576
 v_cvt_pk_bf16_f32 v176, v176, v180
 v_mfma_f32_16x16x32_bf16 v[188:191], v[44:47], v[100:103], v[188:191]
 ds_write_addtid_b32 v176 offset:45056
 v_mul_f32 v178, v178, v5
 v_mfma_f32_16x16x32_bf16 v[192:195], v[16:19], v[48:51], v[192:195]
 ds_read_b128 v[44:47], v3 offset:24576
 v_mul_f32 v182, v182, v6
 v_mfma_f32_16x16x32_bf16 v[196:199], v[16:19], v[52:55], v[196:199]
 v_cvt_pk_bf16_f32 v177, v177, v181
 s_waitcnt lgkmcnt(9)
 v_mfma_f32_16x16x32_bf16 v[192:195], v[20:23], v[64:67], v[192:195]
 ds_read_b128 v[16:19], v8 offset:6144
 v_mul_f32 v179, v179, v5
 v_mfma_f32_16x16x32_bf16 v[196:199], v[20:23], v[68:71], v[196:199]
 ds_write_addtid_b32 v177 offset:45312
 v_mul_f32 v183, v183, v6
 v_mfma_f32_16x16x32_bf16 v[192:195], v[24:27], v[72:75], v[192:195]
 ds_read_b128 v[20:23], v9 offset:6144
 v_cvt_pk_bf16_f32 v178, v178, v182
 v_mfma_f32_16x16x32_bf16 v[196:199], v[24:27], v[76:79], v[196:199]
 ds_write_addtid_b32 v178 offset:45568
 v_cvt_pk_bf16_f32 v179, v179, v183
 s_waitcnt lgkmcnt(9)
 v_mfma_f32_16x16x32_bf16 v[192:195], v[28:31], v[80:83], v[192:195]
 ds_read_b128 v[24:27], v8 offset:43008
 ds_write_addtid_b32 v179 offset:45824
 v_mul_f32 v184, v184, v5
 v_mfma_f32_16x16x32_bf16 v[196:199], v[28:31], v[84:87], v[196:199]
 v_mul_f32 v188, v188, v6
 v_mfma_f32_16x16x32_bf16 v[192:195], v[32:35], v[88:91], v[192:195]
 ds_read_b128 v[28:31], v9 offset:43008
 v_mul_f32 v185, v185, v5
 v_mfma_f32_16x16x32_bf16 v[196:199], v[32:35], v[92:95], v[196:199]
 v_mul_f32 v189, v189, v6
 s_waitcnt lgkmcnt(9)
 v_mfma_f32_16x16x32_bf16 v[192:195], v[36:39], v[96:99], v[192:195]
 ds_read_b128 v[32:35], v2 offset:26624
 v_cvt_pk_bf16_f32 v184, v184, v188
 v_mfma_f32_16x16x32_bf16 v[196:199], v[36:39], v[100:103], v[196:199]
 ds_write_addtid_b32 v184 offset:49152
 v_mul_f32 v186, v186, v5
 s_waitcnt lgkmcnt(3)
 s_cbranch_execz L_sk8
 s_barrier
L_sk8:
 v_mfma_f32_16x16x32_bf16 v[200:203], v[40:43], v[48:51], v[200:203]
 ds_read_b128 v[36:39], v3 offset:26624
 v_mul_f32 v190, v190, v6
 v_mfma_f32_16x16x32_bf16 v[204:207], v[40:43], v[52:55], v[204:207]
 v_cvt_pk_bf16_f32 v185, v185, v189
 v_mfma_f32_16x16x32_bf16 v[200:203], v[44:47], v[64:67], v[200:203]
 ds_read_b128 v[40:43], v8 offset:8192
 v_mul_f32 v187, v187, v5
 v_mfma_f32_16x16x32_bf16 v[204:207], v[44:47], v[68:71], v[204:207]
 ds_write_addtid_b32 v185 offset:49408
 v_mul_f32 v191, v191, v6
 v_mfma_f32_16x16x32_bf16 v[200:203], v[16:19], v[72:75], v[200:203]
 ds_read_b128 v[44:47], v9 offset:8192
 v_cvt_pk_bf16_f32 v186, v186, v190
 v_mfma_f32_16x16x32_bf16 v[204:207], v[16:19], v[76:79], v[204:207]
 ds_write_addtid_b32 v186 offset:49664
 v_cvt_pk_bf16_f32 v187, v187, v191
 v_mfma_f32_16x16x32_bf16 v[200:203], v[20:23], v[80:83], v[200:203]
 ds_read_b128 v[16:19], v8 offset:45056
 ds_write_addtid_b32 v187 offset:49920
 v_mul_f32 v192, v192, v5
 v_mfma_f32_16x16x32_bf16 v[204:207], v[20:23], v[84:87], v[204:207]
 v_mul_f32 v196, v196, v6
 v_mfma_f32_16x16x32_bf16 v[200:203], v[24:27], v[88:91], v[200:203]
 ds_read_b128 v[20:23], v9 offset:45056
 v_mul_f32 v193, v193, v5
 v_mfma_f32_16x16x32_bf16 v[204:207], v[24:27], v[92:95], v[204:207]
 v_mul_f32 v197, v197, v6
 s_cbranch_execz L_dry_done
L_dry2:
 s_waitcnt lgkmcnt(9)
 v_mfma_f32_16x16x32_bf16 v[200:203], v[28:31], v[96:99], v[200:203]
 ds_read_b128 v[24:27], v2 offset:28672
 v_cvt_pk_bf16_f32 v192, v192, v196
 v_mfma_f32_16x16x32_bf16 v[204:207], v[28:31], v[100:103], v[204:207]
 ds_write_addtid_b32 v192 offset:53248
 v_mul_f32 v194, v194, v5
 v_mfma_f32_16x16x32_bf16 v[208:211], v[32:35], v[48:51], v[208:211]
 ds_read_b128 v[28:31], v3 offset:28672
 v_mul_f32 v198, v198, v6
 v_mfma_f32_16x16x32_bf16 v[212:215], v[32:35], v[52:55], v[212:215]
 v_cvt_pk_bf16_f32 v193, v193, v197
 s_waitcnt lgkmcnt(9)
 v_mfma_f32_16x16x32_bf16 v[208:211], v[36:39], v[64:67], v[208:211]
 ds_read_b128 v[32:35], v8 offset:10240
 v_mul_f32 v195, v195, v5
 v_mfma_f32_16x16x32_bf16 v[212:215], v[36:39], v[68:71], v[212:215]
 ds_write_addtid_b32 v193 offset:53504
 v_mul_f32 v199, v199, v6
 v_mfma_f32_16x16x32_bf16 v[208:211], v[40:43], v[72:75], v[208:211]
 ds_read_b128 v[36:39], v9 offset:10240
 v_cvt_pk_bf16_f32 v194, v194, v198
 v_mfma_f32_16x16x32_bf16 v[212:215], v[40:43], v[76:79], v[212:215]
 ds_write_addtid_b32 v194 offset:53760
 v_cvt_pk_bf16_f32 v195, v195, v199
 s_waitcnt lgkmcnt(9)
 v_mfma_f32_16x16x32_bf16 v[208:211], v[44:47], v[80:83], v[208:211]
 ds_read_b128 v[40:43], v8 offset:47104
 ds_write_addtid_b32 v195 offset:54016
 v_mul_f32 v200, v200, v5
 v_mfma_f32_16x16x32_bf16 v[212:215], v[44:47], v[84:87], v[212:215]
 v_mul_f32 v204, v204, v6
 v_mfma_f32_16x16x32_bf16 v[208:211], v[16:19], v[88:91], v[208:211]
 ds_read_b128 v[44:47], v9 offset:47104
 v_mul_f32 v201, v201, v5
 v_mfma_f32_16x16x32_bf16 v[212:215], v[16:19], v[92:95], v[212:215]
 v_mul_f32 v205, v205, v6
 s_waitcnt lgkmcnt(9)
 v_mfma_f32_16x16x32_bf16 v[208:211], v[20:23], v[96:99], v[208:211]
 ds_read_b128 v[16:19], v2 offset:30720
 v_cvt_pk_bf16_f32 v200, v200, v204
 v_mfma_f32_16x16x32_bf16 v[212:215], v[20:23], v[100:103], v[212:215]
 ds_write_addtid_b32 v200 offset:57344
 v_mul_f32 v202, v202, v5
 s_waitcnt lgkmcnt(3)
 s_cbranch_execz L_sk9
 s_barrier
L_sk9:
 v_mfma_f32_16x16x32_bf16 v[216:219], v[24:27], v[48:51], v[216:219]
 ds_read_b128 v[20:23], v3 offset:30720
 v_mul_f32 v206, v206, v6
 v_mfma_f32_16x16x32_bf16 v[220:223], v[24:27], v[52:55], v[220:223]
 v_cvt_pk_bf16_f32 v201, v201, v205
 v_mfma_f32_16x16x32_bf16 v[216:219], v[28:31], v[64:67], v[216:219]
 ds_read_b128 v[24:27], v8 offset:12288
 v_mul_f32 v203, v203, v5
 v_mfma_f32_16x16x32_bf16 v[220:223], v[28:31], v[68:71], v[220:223]
 ds_write_addtid_b32 v201 offset:57600
 v_mul_f32 v207, v207, v6
 v_mfma_f32_16x16x32_bf16 v[216:219], v[32:35], v[72:75], v[216:219]
 ds_read_b128 v[28:31], v9 offset:12288
 v_cvt_pk_bf16_f32 v202, v202, v206
 v_mfma_f32_16x16x32_bf16 v[220:223], v[32:35], v[76:79], v[220:223]
 ds_write_addtid_b32 v202 offset:57856
 v_cvt_pk_bf16_f32 v203, v203, v207
 v_mfma_f32_16x16x32_bf16 v[216:219], v[36:39], v[80:83], v[216:219]
 ds_read_b128 v[32:35], v8 offset:49152
 ds_write_addtid_b32 v203 offset:58112
 v_mul_f32 v208, v208, v5
 v_mfma_f32_16x16x32_bf16 v[220:223], v[36:39], v[84:87], v[220:223]
 v_mul_f32 v212, v212, v6
 v_mfma_f32_16x16x32_bf16 v[216:219], v[40:43], v[88:91], v[216:219]
 ds_read_b128 v[36:39], v9 offset:49152
 v_mul_f32 v209, v209, v5
 v_mfma_f32_16x16x32_bf16 v[220:223], v[40:43], v[92:95], v[220:223]
 v_mul_f32 v213, v213, v6
 s_waitcnt lgkmcnt(9)
 v_mfma_f32_16x16x32_bf16 v[216:219], v[44:47], v[96:99], v[216:219]
 ds_read_b128 v[40:43], v2 offset:32768
 v_cvt_pk_bf16_f32 v208, v208, v212
 v_mfma_f32_16x16x32_bf16 v[220:223], v[44:47], v[100:103], v[220:223]
 ds_write_addtid_b32 v208 offset:61440
 v_mul_f32 v210, v210, v5
 v_mfma_f32_16x16x32_bf16 v[224:227], v[16:19], v[48:51], v[224:227]
 ds_read_b128 v[44:47], v3 offset:32768
 v_mul_f32 v214, v214, v6
 v_mfma_f32_16x16x32_bf16 v[228:231], v[16:19], v[52:55], v[228:231]
 v_cvt_pk_bf16_f32 v209, v209, v213
 s_waitcnt lgkmcnt(9)
 v_mfma_f32_16x16x32_bf16 v[224:227], v[20:23], v[64:67], v[224:227]
 ds_read_b128 v[16:19], v8 offset:14336
 v_mul_f32 v211, v211, v5
 v_mfma_f32_16x16x32_bf16 v[228:231], v[20:23], v[68:71], v[228:231]
 ds_write_addtid_b32 v209 offset:61696
 v_mul_f32 v215, v215, v6
 v_mfma_f32_16x16x32_bf16 v[224:227], v[24:27], v[72:75], v[224:227]
 ds_read_b128 v[20:23], v9 offset:14336
 v_cvt_pk_bf16_f32 v210, v210, v214
 v_mfma_f32_16x16x32_bf16 v[228:231], v[24:27], v[76:79], v[228:231]
 ds_write_addtid_b32 v210 offset:61952
 v_cvt_pk_bf16_f32 v211, v211, v215
 s_waitcnt lgkmcnt(9)
 v_mfma_f32_16x16x32_bf16 v[224:227], v[28:31], v[80:83], v[224:227]
 ds_read_b128 v[24:27], v8 offset:51200
 ds_write_addtid_b32 v211 offset:62208
 v_mul_f32 v216, v216, v5
 v_mfma_f32_16x16x32_bf16 v[228:231], v[28:31], v[84:87], v[228:231]
 v_mul_f32 v220, v220, v6
 v_mfma_f32_16x16x32_bf16 v[224:227], v[32:35], v[88:91], v[224:227]
 ds_read_b128 v[28:31], v9 offset:51200
 v_mul_f32 v217, v217, v5
 v_mfma_f32_16x16x32_bf16 v[228:231], v[32:35], v[92:95], v[228:231]
 v_mul_f32 v221, v221, v6
 s_waitcnt lgkmcnt(9)
 v_mfma_f32_16x16x32_bf16 v[224:227], v[36:39], v[96:99], v[224:227]
 ds_read_b128 v[32:35], v2 offset:34816
 v_cvt_pk_bf16_f32 v216, v216, v220
 v_mfma_f32_16x16x32_bf16 v[228:231], v[36:39], v[100:103], v[228:231]
 ds_write_addtid_b32 v216 offset:16384
 v_mul_f32 v218, v218, v5
 s_waitcnt lgkmcnt(3)
 s_cbranch_execz L_sk10
 s_barrier
L_sk10:
 v_mfma_f32_16x16x32_bf16 v[232:235], v[40:43], v[48:51], v[232:235]
 ds_read_b128 v[36:39], v3 offset:34816
 v_mul_f32 v222, v222, v6
 v_mfma_f32_16x16x32_bf16 v[236:239], v[40:43], v[52:55], v[236:239]
 v_cvt_pk_bf16_f32 v217, v217, v221
 v_mfma_f32_16x16x32_bf16 v[232:235], v[44:47], v[64:67], v[232:235]
 ds_read_b128 v[40:43], v8 offset:16384
 v_mul_f32 v219, v219, v5
 v_mfma_f32_16x16x32_bf16 v[236:239], v[44:47], v[68:71], v[236:239]
 ds_write_addtid_b32 v217 offset:16640
 v_mul_f32 v223, v223, v6
 v_mfma_f32_16x16x32_bf16 v[232:235], v[16:19], v[72:75], v[232:235]
 ds_read_b128 v[44:47], v9 offset:16384
 v_cvt_pk_bf16_f32 v218, v218, v222
 v_mfma_f32_16x16x32_bf16 v[236:239], v[16:19], v[76:79], v[236:239]
 ds_write_addtid_b32 v218 offset:16896
 v_cvt_pk_bf16_f32 v219, v219, v223
 v_mfma_f32_16x16x32_bf16 v[232:235], v[20:23], v[80:83], v[232:235]
 ds_read_b128 v[16:19], v8 offset:53248
 ds_write_addtid_b32 v219 offset:17152
 v_mul_f32 v224, v224, v5
 v_mfma_f32_16x16x32_bf16 v[236:239], v[20:23], v[84:87], v[236:239]
 v_mul_f32 v228, v228, v6
 v_mfma_f32_16x16x32_bf16 v[232:235], v[24:27], v[88:91], v[232:235]
 ds_read_b128 v[20:23], v9 offset:53248
 v_mul_f32 v225, v225, v5
 v_mfma_f32_16x16x32_bf16 v[236:239], v[24:27], v[92:95], v[236:239]
 v_mul_f32 v229, v229, v6
 s_waitcnt lgkmcnt(9)
 v_mfma_f32_16x16x32_bf16 v[232:235], v[28:31], v[96:99], v[232:235]
 ds_read_b128 v[24:27], v0
 v_xor_b32 v0, 64, v0
 v_cvt_pk_bf16_f32 v224, v224, v228
 v_mfma_f32_16x16x32_bf16 v[236:239], v[28:31], v[100:103], v[236:239]
 ds_write_addtid_b32 v224 offset:20480
 v_mul_f32 v226, v226, v5
 v_mfma_f32_16x16x32_bf16 v[240:243], v[32:35], v[48:51], v[240:243]
 ds_read_b128 v[28:31], v0
 v_xor_b32 v0, 2112, v0
 v_mul_f32 v230, v230, v6
 v_mfma_f32_16x16x32_bf16 v[244:247], v[32:35], v[52:55], v[244:247]
 v_cvt_pk_bf16_f32 v225, v225, v229
 s_waitcnt lgkmcnt(9)
 v_mfma_f32_16x16x32_bf16 v[240:243], v[36:39], v[64:67], v[240:243]
 ds_read_b128 v[32:35], v0
 v_xor_b32 v0, 64, v0
 v_mul_f32 v227, v227, v5
 v_mfma_f32_16x16x32_bf16 v[244:247], v[36:39], v[68:71], v[244:247]
 ds_write_addtid_b32 v225 offset:20736
 v_mul_f32 v231, v231, v6
 v_mfma_f32_16x16x32_bf16 v[240:243], v[40:43], v[72:75], v[240:243]
 ds_read_b128 v[36:39], v0
 v_xor_b32 v0, 2112, v0
 v_cvt_pk_bf16_f32 v226, v226, v230
 v_mfma_f32_16x16x32_bf16 v[244:247], v[40:43], v[76:79], v[244:247]
 ds_write_addtid_b32 v226 offset:20992
 v_cvt_pk_bf16_f32 v227, v227, v231
 s_waitcnt lgkmcnt(9)
 v_mfma_f32_16x16x32_bf16 v[240:243], v[44:47], v[80:83], v[240:243]
 ds_read_b128 v[40:43], v2
 ds_write_addtid_b32 v227 offset:21248
 v_mul_f32 v232, v232, v5
 v_mfma_f32_16x16x32_bf16 v[244:247], v[44:47], v[84:87], v[244:247]
 v_mul_f32 v236, v236, v6
 v_mfma_f32_16x16x32_bf16 v[240:243], v[16:19], v[88:91], v[240:243]
 ds_read_b128 v[44:47], v3
 v_mul_f32 v233, v233, v5
 v_mfma_f32_16x16x32_bf16 v[244:247], v[16:19], v[92:95], v[244:247]
 v_mul_f32 v237, v237, v6
 s_waitcnt lgkmcnt(9)
 v_mfma_f32_16x16x32_bf16 v[240:243], v[20:23], v[96:99], v[240:243]
 v_cvt_pk_bf16_f32 v232, v232, v236
 v_mfma_f32_16x16x32_bf16 v[244:247], v[20:23], v[100:103], v[244:247]
 ds_write_addtid_b32 v232 offset:24576
 v_mul_f32 v234, v234, v5
 s_waitcnt lgkmcnt(2)
 s_cbranch_execz L_sk11
 s_barrier
L_sk11:
 s_cmp_ge_u32 s36, 2
 s_cbranch_scc1 L_x17
 v_mfma_f32_16x16x32_bf16 v[248:251], v[24:27], v[48:51], v[248:251]
 v_mul_f32 v238, v238, v6
 v_mfma_f32_16x16x32_bf16 v[252:255], v[24:27], v[52:55], v[252:255]
 v_cvt_pk_bf16_f32 v233, v233, v237
 v_mfma_f32_16x16x32_bf16 v[248:251], v[28:31], v[64:67], v[248:251]
 ds_write_addtid_b32 v233 offset:24832
 v_mul_f32 v235, v235, v5
 v_mfma_f32_16x16x32_bf16 v[252:255], v[28:31], v[68:71], v[252:255]
 v_mul_f32 v239, v239, v6
 v_mfma_f32_16x16x32_bf16 v[248:251], v[32:35], v[72:75], v[248:251]
 v_cvt_pk_bf16_f32 v234, v234, v238
 v_mfma_f32_16x16x32_bf16 v[252:255], v[32:35], v[76:79], v[252:255]
 ds_write_addtid_b32 v234 offset:25088
 v_cvt_pk_bf16_f32 v235, v235, v239
 v_mfma_f32_16x16x32_bf16 v[248:251], v[36:39], v[80:83], v[248:251]
 ds_write_addtid_b32 v235 offset:25344
 v_mul_f32 v240, v240, v5
 v_mfma_f32_16x16x32_bf16 v[252:255], v[36:39], v[84:87], v[252:255]
 v_mul_f32 v244, v244, v6
 v_mfma_f32_16x16x32_bf16 v[248:251], v[40:43], v[88:91], v[248:251]
 v_mul_f32 v241, v241, v5
 v_mfma_f32_16x16x32_bf16 v[252:255], v[40:43], v[92:95], v[252:255]
 v_mul_f32 v245, v245, v6
 s_waitcnt lgkmcnt(4)
 v_mfma_f32_16x16x32_bf16 v[248:251], v[44:47], v[96:99], v[248:251]
 v_cvt_pk_bf16_f32 v240, v240, v244
 v_mfma_f32_16x16x32_bf16 v[252:255], v[44:47], v[100:103], v[252:255]
 ds_write_addtid_b32 v240 offset:28672
 v_mul_f32 v242, v242, v5
 v_mul_f32 v246, v246, v6
 v_cvt_pk_bf16_f32 v241, v241, v245
 v_mul_f32 v243, v243, v5
 v_mul_f32 v247, v247, v6
 v_cvt_pk_bf16_f32 v242, v242, v246
 ds_write_addtid_b32 v241 offset:28928
 v_cvt_pk_bf16_f32 v243, v243, v247
 ds_write_addtid_b32 v242 offset:29184
 ds_write_addtid_b32 v243 offset:29440
 s_nop 7
 v_mul_f32 v248, v248, v5
 v_mul_f32 v252, v252, v6
 v_mul_f32 v249, v249, v5
 v_mul_f32 v253, v253, v6
 v_mul_f32 v250, v250, v5
 v_mul_f32 v254, v254, v6
 v_mul_f32 v251, v251, v5
 v_mul_f32 v255, v255, v6
 v_cvt_pk_bf16_f32 v248, v248, v252
 v_cvt_pk_bf16_f32 v249, v249, v253
 v_cvt_pk_bf16_f32 v250, v250, v254
 v_cvt_pk_bf16_f32 v251, v251, v255
 s_cbranch_execz L_x17
 buffer_store_dword v248, v7, s[24:27], 0 offen sc0 sc1
 buffer_store_dword v249, v7, s[24:27], s52 offen sc0 sc1
 buffer_store_dword v250, v7, s[24:27], s53 offen sc0 sc1
 buffer_store_dword v251, v7, s[24:27], s54 offen sc0 sc1
 s_waitcnt lgkmcnt(0)
 s_barrier
 s_endpgm
L_x17:
 v_mul_f32 v238, v238, v6
 v_cvt_pk_bf16_f32 v233, v233, v237
 v_mul_f32 v235, v235, v5
 v_mul_f32 v239, v239, v6
 v_cvt_pk_bf16_f32 v234, v234, v238
 ds_write_addtid_b32 v233 offset:24832
 v_cvt_pk_bf16_f32 v235, v235, v239
 ds_write_addtid_b32 v234 offset:25088
 ds_write_addtid_b32 v235 offset:25344
 s_nop 7
 v_mul_f32 v240, v240, v5
 v_mul_f32 v244, v244, v6
 v_mul_f32 v241, v241, v5
 v_mul_f32 v245, v245, v6
 v_mul_f32 v242, v242, v5
 v_mul_f32 v246, v246, v6
 v_mul_f32 v243, v243, v5
 v_mul_f32 v247, v247, v6
 v_cvt_pk_bf16_f32 v240, v240, v244
 v_cvt_pk_bf16_f32 v241, v241, v245
 v_cvt_pk_bf16_f32 v242, v242, v246
 v_cvt_pk_bf16_f32 v243, v243, v247
 s_cbranch_execz L_dx
 buffer_store_dword v240, v7, s[24:27], 0 offen sc0 sc1
 buffer_store_dword v241, v7, s[24:27], s52 offen sc0 sc1
 buffer_store_dword v242, v7, s[24:27], s53 offen sc0 sc1
 buffer_store_dword v243, v7, s[24:27], s54 offen sc0 sc1
 s_waitcnt lgkmcnt(0)
 s_barrier
 s_endpgm
L_dx:
 s_branch L_dry_done
L_end:
 s_endpgm
 .p2align 12
L_p2:
 v_bfe_u32 v16, v1, 3, 2
 v_lshlrev_b32 v16, 10, v16
 v_and_b32 v17, 7, v1
 v_lshl_add_u32 v16, v17, 4, v16
 v_lshrrev_b32 v17, 5, v1
 v_lshl_add_u32 v16, v17, 8, v16
 s_lshr_b32 s59, s51, 1
 s_lshl_b32 s59, s59, 12
 s_lshl_b32 s55, s58, 9
 s_add_u32 s59, s59, s55
 s_add_u32 s59, s59, 69632
 v_add_u32 v4, s59, v16
 v_and_b32 v16, 7, v1
 v_lshlrev_b32 v16, 3, v16
 v_lshl_add_u32 v16, v17, 6, v16
 v_lshl_or_b32 v7, v16, 16, v16
 v_add_u32 v8, 0x00040004, v7
 s_lshl_b32 s47, s51, 11
 s_add_u32 s47, s47, 36864
 s_mov_b32 s24, s10
 s_mov_b32 s25, s11
 s_mov_b32 s26, 18874368
 s_mov_b32 s27, 0x20000
 v_bfe_u32 v12, v1, 2, 2
 v_lshlrev_b32 v12, 10, v12
 v_lshrrev_b32 v13, 4, v1
 v_lshl_add_u32 v12, v13, 6, v12
 v_and_b32 v14, 3, v1
 v_lshl_add_u32 v12, v14, 4, v12
 s_lshl_b32 s55, s51, 8
 s_add_u32 s55, s55, 77824
 v_add_u32 v5, s55, v12
 v_mul_u32_u24 v13, 36864, v13
 v_and_b32 v14, 15, v1
 v_lshl_add_u32 v13, v14, 4, v13
 s_lshl_b32 s54, s37, 4
 s_add_u32 s54, s54, s51
 s_mul_i32 s54, s54, 9216
 s_lshl_b32 s55, s35, 8
 s_add_u32 s54, s54, s55
 v_add_u32 v6, s54, v13
 buffer_load_format_d16_xyzw v[48:49], v2, s[20:23], 0 offen
 buffer_load_format_d16_xyzw v[50:51], v2, s[20:23], s94 offen
 buffer_load_format_d16_xyzw v[52:53], v2, s[20:23], s95 offen
 buffer_load_format_d16_xyzw v[54:55], v2, s[20:23], s96 offen
 buffer_load_format_d16_xyzw v[56:57], v2, s[20:23], s97 offen
 buffer_load_format_d16_xyzw v[58:59], v2, s[20:23], s98 offen
 buffer_load_format_d16_xyzw v[60:61], v2, s[20:23], s99 offen
 buffer_load_format_d16_xyzw v[62:63], v2, s[20:23], s100 offen
 s_cmp_eq_u32 s28, 8
 s_cselect_b32 s3, s12, s13
 s_add_u32 s28, s28, 1
 v_add_u32 v2, s3, v2
 s_waitcnt vmcnt(21)
 v_lshl_or_b32 v96, v32, 7, v7
 v_lshl_or_b32 v100, v33, 7, v8
 v_lshl_or_b32 v97, v36, 7, v7
 v_lshl_or_b32 v101, v37, 7, v8
 v_lshl_or_b32 v96, v34, 11, v96
 v_lshl_or_b32 v100, v35, 11, v100
 v_lshl_or_b32 v97, v38, 11, v97
 v_lshl_or_b32 v101, v39, 11, v101
 s_waitcnt vmcnt(17)
 v_lshl_or_b32 v98, v40, 7, v7
 v_lshl_or_b32 v102, v41, 7, v8
 v_lshl_or_b32 v99, v44, 7, v7
 v_lshl_or_b32 v103, v45, 7, v8
 v_lshl_or_b32 v98, v42, 11, v98
 v_lshl_or_b32 v102, v43, 11, v102
 v_lshl_or_b32 v99, v46, 11, v99
 v_lshl_or_b32 v103, v47, 11, v103
 ds_write_b128 v4, v[96:99] offset:0
 ds_write_b128 v4, v[100:103] offset:128
 s_waitcnt lgkmcnt(0)
 s_barrier
 buffer_load_format_d16_xyzw v[32:33], v2, s[20:23], 0 offen
 buffer_load_format_d16_xyzw v[34:35], v2, s[20:23], s94 offen
 buffer_load_format_d16_xyzw v[36:37], v2, s[20:23], s95 offen
 buffer_load_format_d16_xyzw v[38:39], v2, s[20:23], s96 offen
 buffer_load_format_d16_xyzw v[40:41], v2, s[20:23], s97 offen
 buffer_load_format_d16_xyzw v[42:43], v2, s[20:23], s98 offen
 buffer_load_format_d16_xyzw v[44:45], v2, s[20:23], s99 offen
 buffer_load_format_d16_xyzw v[46:47], v2, s[20:23], s100 offen
 s_cmp_eq_u32 s28, 8
 s_cselect_b32 s3, s12, s13
 s_add_u32 s28, s28, 1
 v_add_u32 v2, s3, v2
 s_waitcnt vmcnt(12)
 v_lshl_or_b32 v96, v48, 7, v7
 v_lshl_or_b32 v100, v49, 7, v8
 v_lshl_or_b32 v97, v52, 7, v7
 v_lshl_or_b32 v101, v53, 7, v8
 v_lshl_or_b32 v96, v50, 11, v96
 v_lshl_or_b32 v100, v51, 11, v100
 v_lshl_or_b32 v97, v54, 11, v97
 v_lshl_or_b32 v101, v55, 11, v101
 s_waitcnt vmcnt(8)
 v_lshl_or_b32 v98, v56, 7, v7
 v_lshl_or_b32 v102, v57, 7, v8
 v_lshl_or_b32 v99, v60, 7, v7
 v_lshl_or_b32 v103, v61, 7, v8
 v_lshl_or_b32 v98, v58, 11, v98
 v_lshl_or_b32 v102, v59, 11, v102
 v_lshl_or_b32 v99, v62, 11, v99
 v_lshl_or_b32 v103, v63, 11, v103
 ds_write_b128 v4, v[96:99] offset:8192
 ds_write_b128 v4, v[100:103] offset:8320
 s_mov_b32 s53, s40
 s_mov_b32 s57, s29
 s_add_u32 s29, s29, 128
 s_cmp_eq_u32 s29, 1152
 s_cselect_b32 s29, 0, s29
 s_mov_b32 s3, s40
 s_mov_b32 s40, s41
 s_mov_b32 s41, s42
 s_mov_b32 s42, s3
 s_waitcnt lgkmcnt(0)
 s_barrier
 s_mov_b32 m0, s53
 s_add_u32 s53, s53, 36864
 buffer_load_dwordx4 v3, s[16:19], s57 offen lds
 s_addk_i32 m0, 4096
 s_add_u32 s57, s57, s95
 buffer_load_dwordx4 v3, s[16:19], s57 offen lds
 s_addk_i32 m0, 4096
 s_add_u32 s57, s57, s95
 buffer_load_dwordx4 v3, s[16:19], s57 offen lds
 s_addk_i32 m0, 4096
 s_add_u32 s57, s57, s95
 buffer_load_dwordx4 v3, s[16:19], s57 offen lds
 s_addk_i32 m0, 4096
 s_add_u32 s57, s57, s95
 buffer_load_dwordx4 v3, s[16:19], s57 offen lds
 s_addk_i32 m0, 4096
 s_add_u32 s57, s57, s95
 buffer_load_dwordx4 v3, s[16:19], s57 offen lds
 s_addk_i32 m0, 4096
 s_add_u32 s57, s57, s95
 buffer_load_dwordx4 v3, s[16:19], s57 offen lds
 s_addk_i32 m0, 4096
 s_add_u32 s57, s57, s95
 buffer_load_dwordx4 v3, s[16:19], s57 offen lds
 s_addk_i32 m0, 4096
 s_add_u32 s57, s57, s95
 buffer_load_dwordx4 v3, s[16:19], s57 offen lds
 s_add_u32 s57, s57, s95
 s_cmp_eq_u32 s32, 0
 s_cbranch_scc1 L_e2
 s_mov_b32 m0, s43
 s_add_u32 s3, s33, 331776
 buffer_load_dwordx4 v3, s[16:19], s3 offen lds
 s_add_u32 s33, s33, 128
 s_cmp_eq_u32 s33, 1152
 s_cselect_b32 s33, 0, s33
 s_xor_b32 s43, s43, 2048
L_e2:
 buffer_load_format_d16_xyzw v[48:49], v2, s[20:23], 0 offen
 buffer_load_format_d16_xyzw v[50:51], v2, s[20:23], s94 offen
 buffer_load_format_d16_xyzw v[52:53], v2, s[20:23], s95 offen
 buffer_load_format_d16_xyzw v[54:55], v2, s[20:23], s96 offen
 buffer_load_format_d16_xyzw v[56:57], v2, s[20:23], s97 offen
 buffer_load_format_d16_xyzw v[58:59], v2, s[20:23], s98 offen
 buffer_load_format_d16_xyzw v[60:61], v2, s[20:23], s99 offen
 buffer_load_format_d16_xyzw v[62:63], v2, s[20:23], s100 offen
 s_cmp_eq_u32 s28, 8
 s_cselect_b32 s3, s12, s13
 s_add_u32 s28, s28, 1
 v_add_u32 v2, s3, v2
 s_waitcnt vmcnt(21)
 v_lshl_or_b32 v96, v32, 7, v7
 v_lshl_or_b32 v100, v33, 7, v8
 v_lshl_or_b32 v97, v36, 7, v7
 v_lshl_or_b32 v101, v37, 7, v8
 v_lshl_or_b32 v96, v34, 11, v96
 v_lshl_or_b32 v100, v35, 11, v100
 v_lshl_or_b32 v97, v38, 11, v97
 v_lshl_or_b32 v101, v39, 11, v101
 s_waitcnt vmcnt(17)
 v_lshl_or_b32 v98, v40, 7, v7
 v_lshl_or_b32 v102, v41, 7, v8
 v_lshl_or_b32 v99, v44, 7, v7
 v_lshl_or_b32 v103, v45, 7, v8
 v_lshl_or_b32 v98, v42, 11, v98
 v_lshl_or_b32 v102, v43, 11, v102
 v_lshl_or_b32 v99, v46, 11, v99
 v_lshl_or_b32 v103, v47, 11, v103
 s_waitcnt vmcnt(8)
 ds_write_b128 v4, v[96:99] offset:0
 ds_write_b128 v4, v[100:103] offset:128
 s_mov_b32 s53, s40
 s_mov_b32 s57, s29
 s_add_u32 s29, s29, 128
 s_cmp_eq_u32 s29, 1152
 s_cselect_b32 s29, 0, s29
 s_mov_b32 s3, s40
 s_mov_b32 s40, s41
 s_mov_b32 s41, s42
 s_mov_b32 s42, s3
 s_mov_b32 m0, s53
 s_add_u32 s53, s53, 12288
 buffer_load_dwordx4 v3, s[16:19], s57 offen lds
 s_addk_i32 m0, 4096
 s_add_u32 s57, s57, s95
 buffer_load_dwordx4 v3, s[16:19], s57 offen lds
 s_addk_i32 m0, 4096
 s_add_u32 s57, s57, s95
 buffer_load_dwordx4 v3, s[16:19], s57 offen lds
 s_add_u32 s57, s57, s95
 s_waitcnt vmcnt(11) lgkmcnt(0)
 s_barrier
 s_mov_b32 m0, s53
 s_add_u32 s53, s53, 24576
 buffer_load_dwordx4 v3, s[16:19], s57 offen lds
 s_addk_i32 m0, 4096
 s_add_u32 s57, s57, s95
 buffer_load_dwordx4 v3, s[16:19], s57 offen lds
 s_addk_i32 m0, 4096
 s_add_u32 s57, s57, s95
 buffer_load_dwordx4 v3, s[16:19], s57 offen lds
 s_addk_i32 m0, 4096
 s_add_u32 s57, s57, s95
 buffer_load_dwordx4 v3, s[16:19], s57 offen lds
 s_addk_i32 m0, 4096
 s_add_u32 s57, s57, s95
 buffer_load_dwordx4 v3, s[16:19], s57 offen lds
 s_addk_i32 m0, 4096
 s_add_u32 s57, s57, s95
 buffer_load_dwordx4 v3, s[16:19], s57 offen lds
 s_add_u32 s57, s57, s95
 s_mov_b32 s34, 2
L_ploop:
 s_cmp_eq_u32 s32, 0
 s_cbranch_scc1 L_e3
 s_mov_b32 m0, s43
 s_add_u32 s3, s33, 331776
 buffer_load_dwordx4 v3, s[16:19], s3 offen lds
 s_add_u32 s33, s33, 128
 s_cmp_eq_u32 s33, 1152
 s_cselect_b32 s33, 0, s33
 s_xor_b32 s43, s43, 2048
L_e3:
 buffer_load_format_d16_xyzw v[32:33], v2, s[20:23], 0 offen
 buffer_load_format_d16_xyzw v[34:35], v2, s[20:23], s94 offen
 buffer_load_format_d16_xyzw v[36:37], v2, s[20:23], s95 offen
 buffer_load_format_d16_xyzw v[38:39], v2, s[20:23], s96 offen
 buffer_load_format_d16_xyzw v[40:41], v2, s[20:23], s97 offen
 buffer_load_format_d16_xyzw v[42:43], v2, s[20:23], s98 offen
 buffer_load_format_d16_xyzw v[44:45], v2, s[20:23], s99 offen
 buffer_load_format_d16_xyzw v[46:47], v2, s[20:23], s100 offen
 s_cmp_eq_u32 s28, 8
 s_cselect_b32 s3, s12, s13
 s_add_u32 s28, s28, 1
 v_add_u32 v2, s3, v2
 s_waitcnt vmcnt(21)
 v_lshl_or_b32 v96, v48, 7, v7
 v_lshl_or_b32 v100, v49, 7, v8
 v_lshl_or_b32 v97, v52, 7, v7
 v_lshl_or_b32 v101, v53, 7, v8
 v_lshl_or_b32 v96, v50, 11, v96
 v_lshl_or_b32 v100, v51, 11, v100
 v_lshl_or_b32 v97, v54, 11, v97
 v_lshl_or_b32 v101, v55, 11, v101
 s_waitcnt vmcnt(17)
 v_lshl_or_b32 v98, v56, 7, v7
 v_lshl_or_b32 v102, v57, 7, v8
 v_lshl_or_b32 v99, v60, 7, v7
 v_lshl_or_b32 v103, v61, 7, v8
 v_lshl_or_b32 v98, v58, 11, v98
 v_lshl_or_b32 v102, v59, 11, v102
 v_lshl_or_b32 v99, v62, 11, v99
 v_lshl_or_b32 v103, v63, 11, v103
 s_waitcnt vmcnt(8)
 ds_write_b128 v4, v[96:99] offset:8192
 ds_write_b128 v4, v[100:103] offset:8320
 s_mov_b32 s53, s40
 s_mov_b32 s57, s29
 s_add_u32 s29, s29, 128
 s_cmp_eq_u32 s29, 1152
 s_cselect_b32 s29, 0, s29
 s_mov_b32 s3, s40
 s_mov_b32 s40, s41
 s_mov_b32 s41, s42
 s_mov_b32 s42, s3
 s_mov_b32 m0, s53
 s_add_u32 s53, s53, 36864
 buffer_load_dwordx4 v3, s[16:19], s57 offen lds
 s_addk_i32 m0, 4096
 s_add_u32 s57, s57, s95
 buffer_load_dwordx4 v3, s[16:19], s57 offen lds
 s_addk_i32 m0, 4096
 s_add_u32 s57, s57, s95
 buffer_load_dwordx4 v3, s[16:19], s57 offen lds
 s_addk_i32 m0, 4096
 s_add_u32 s57, s57, s95
 buffer_load_dwordx4 v3, s[16:19], s57 offen lds
 s_addk_i32 m0, 4096
 s_add_u32 s57, s57, s95
 buffer_load_dwordx4 v3, s[16:19], s57 offen lds
 s_addk_i32 m0, 4096
 s_add_u32 s57, s57, s95
 buffer_load_dwordx4 v3, s[16:19], s57 offen lds
 s_addk_i32 m0, 4096
 s_add_u32 s57, s57, s95
 buffer_load_dwordx4 v3, s[16:19], s57 offen lds
 s_addk_i32 m0, 4096
 s_add_u32 s57, s57, s95
 buffer_load_dwordx4 v3, s[16:19], s57 offen lds
 s_addk_i32 m0, 4096
 s_add_u32 s57, s57, s95
 buffer_load_dwordx4 v3, s[16:19], s57 offen lds
 s_add_u32 s57, s57, s95
 s_waitcnt vmcnt(17) lgkmcnt(0)
 s_barrier
 s_cmp_eq_u32 s32, 0
 s_cbranch_scc1 L_e4
 s_mov_b32 m0, s43
 s_add_u32 s3, s33, 331776
 buffer_load_dwordx4 v3, s[16:19], s3 offen lds
 s_add_u32 s33, s33, 128
 s_cmp_eq_u32 s33, 1152
 s_cselect_b32 s33, 0, s33
 s_xor_b32 s43, s43, 2048
L_e4:
 buffer_load_format_d16_xyzw v[48:49], v2, s[20:23], 0 offen
 buffer_load_format_d16_xyzw v[50:51], v2, s[20:23], s94 offen
 buffer_load_format_d16_xyzw v[52:53], v2, s[20:23], s95 offen
 buffer_load_format_d16_xyzw v[54:55], v2, s[20:23], s96 offen
 buffer_load_format_d16_xyzw v[56:57], v2, s[20:23], s97 offen
 buffer_load_format_d16_xyzw v[58:59], v2, s[20:23], s98 offen
 buffer_load_format_d16_xyzw v[60:61], v2, s[20:23], s99 offen
 buffer_load_format_d16_xyzw v[62:63], v2, s[20:23], s100 offen
 s_cmp_eq_u32 s28, 8
 s_cselect_b32 s3, s12, s13
 s_add_u32 s28, s28, 1
 v_add_u32 v2, s3, v2
 s_waitcnt vmcnt(21)
 v_lshl_or_b32 v96, v32, 7, v7
 v_lshl_or_b32 v100, v33, 7, v8
 v_lshl_or_b32 v97, v36, 7, v7
 v_lshl_or_b32 v101, v37, 7, v8
 v_lshl_or_b32 v96, v34, 11, v96
 v_lshl_or_b32 v100, v35, 11, v100
 v_lshl_or_b32 v97, v38, 11, v97
 v_lshl_or_b32 v101, v39, 11, v101
 s_waitcnt vmcnt(17)
 v_lshl_or_b32 v98, v40, 7, v7
 v_lshl_or_b32 v102, v41, 7, v8
 v_lshl_or_b32 v99, v44, 7, v7
 v_lshl_or_b32 v103, v45, 7, v8
 v_lshl_or_b32 v98, v42, 11, v98
 v_lshl_or_b32 v102, v43, 11, v102
 v_lshl_or_b32 v99, v46, 11, v99
 v_lshl_or_b32 v103, v47, 11, v103
 s_waitcnt vmcnt(8)
 ds_write_b128 v4, v[96:99] offset:0
 ds_write_b128 v4, v[100:103] offset:128
 s_mov_b32 s53, s40
 s_mov_b32 s57, s29
 s_add_u32 s29, s29, 128
 s_cmp_eq_u32 s29, 1152
 s_cselect_b32 s29, 0, s29
 s_mov_b32 s3, s40
 s_mov_b32 s40, s41
 s_mov_b32 s41, s42
 s_mov_b32 s42, s3
 s_mov_b32 m0, s53
 s_add_u32 s53, s53, 36864
 buffer_load_dwordx4 v3, s[16:19], s57 offen lds
 s_addk_i32 m0, 4096
 s_add_u32 s57, s57, s95
 buffer_load_dwordx4 v3, s[16:19], s57 offen lds
 s_addk_i32 m0, 4096
 s_add_u32 s57, s57, s95
 buffer_load_dwordx4 v3, s[16:19], s57 offen lds
 s_addk_i32 m0, 4096
 s_add_u32 s57, s57, s95
 buffer_load_dwordx4 v3, s[16:19], s57 offen lds
 s_addk_i32 m0, 4096
 s_add_u32 s57, s57, s95
 buffer_load_dwordx4 v3, s[16:19], s57 offen lds
 s_addk_i32 m0, 4096
 s_add_u32 s57, s57, s95
 buffer_load_dwordx4 v3, s[16:19], s57 offen lds
 s_addk_i32 m0, 4096
 s_add_u32 s57, s57, s95
 buffer_load_dwordx4 v3, s[16:19], s57 offen lds
 s_addk_i32 m0, 4096
 s_add_u32 s57, s57, s95
 buffer_load_dwordx4 v3, s[16:19], s57 offen lds
 s_addk_i32 m0, 4096
 s_add_u32 s57, s57, s95
 buffer_load_dwordx4 v3, s[16:19], s57 offen lds
 s_add_u32 s57, s57, s95
 s_waitcnt vmcnt(17) lgkmcnt(0)
 s_sub_u32 s34, s34, 1
 s_cmp_lg_u32 s34, 0
 s_barrier
 s_cbranch_scc1 L_ploop
 s_mov_b32 s44, s29
 s_add_u32 s29, s29, 128
 s_cmp_eq_u32 s29, 1152
 s_cselect_b32 s29, 0, s29
 s_mov_b32 s45, s29
 s_cmp_eq_u32 s32, 0
 s_cbranch_scc1 L_e5
 s_mov_b32 m0, s43
 s_add_u32 s3, s33, 331776
 buffer_load_dwordx4 v3, s[16:19], s3 offen lds
 s_add_u32 s33, s33, 128
 s_cmp_eq_u32 s33, 1152
 s_cselect_b32 s33, 0, s33
 s_xor_b32 s43, s43, 2048
L_e5:
 buffer_load_format_d16_xyzw v[32:33], v2, s[20:23], 0 offen
 buffer_load_format_d16_xyzw v[34:35], v2, s[20:23], s94 offen
 buffer_load_format_d16_xyzw v[36:37], v2, s[20:23], s95 offen
 buffer_load_format_d16_xyzw v[38:39], v2, s[20:23], s96 offen
 buffer_load_format_d16_xyzw v[40:41], v2, s[20:23], s97 offen
 buffer_load_format_d16_xyzw v[42:43], v2, s[20:23], s98 offen
 buffer_load_format_d16_xyzw v[44:45], v2, s[20:23], s99 offen
 buffer_load_format_d16_xyzw v[46:47], v2, s[20:23], s100 offen
 s_cmp_eq_u32 s28, 8
 s_cselect_b32 s3, s12, s13
 s_add_u32 s28, s28, 1
 v_add_u32 v2, s3, v2
 s_waitcnt vmcnt(21)
 v_lshl_or_b32 v96, v48, 7, v7
 v_lshl_or_b32 v100, v49, 7, v8
 v_lshl_or_b32 v97, v52, 7, v7
 v_lshl_or_b32 v101, v53, 7, v8
 v_lshl_or_b32 v96, v50, 11, v96
 v_lshl_or_b32 v100, v51, 11, v100
 v_lshl_or_b32 v97, v54, 11, v97
 v_lshl_or_b32 v101, v55, 11, v101
 s_waitcnt vmcnt(17)
 v_lshl_or_b32 v98, v56, 7, v7
 v_lshl_or_b32 v102, v57, 7, v8
 v_lshl_or_b32 v99, v60, 7, v7
 v_lshl_or_b32 v103, v61, 7, v8
 v_lshl_or_b32 v98, v58, 11, v98
 v_lshl_or_b32 v102, v59, 11, v102
 v_lshl_or_b32 v99, v62, 11, v99
 v_lshl_or_b32 v103, v63, 11, v103
 s_waitcnt vmcnt(8)
 ds_write_b128 v4, v[96:99] offset:8192
 ds_write_b128 v4, v[100:103] offset:8320
 s_mov_b32 m0, s40
 s_addk_i32 s40, 4096
 buffer_load_dwordx4 v3, s[16:19], s44 offen lds
 s_add_u32 s44, s44, s95
 s_mov_b32 m0, s40
 s_addk_i32 s40, 4096
 buffer_load_dwordx4 v3, s[16:19], s44 offen lds
 s_add_u32 s44, s44, s95
 s_mov_b32 m0, s40
 s_addk_i32 s40, 4096
 buffer_load_dwordx4 v3, s[16:19], s44 offen lds
 s_add_u32 s44, s44, s95
 s_mov_b32 m0, s40
 s_addk_i32 s40, 4096
 buffer_load_dwordx4 v3, s[16:19], s44 offen lds
 s_add_u32 s44, s44, s95
 s_mov_b32 m0, s40
 s_addk_i32 s40, 4096
 buffer_load_dwordx4 v3, s[16:19], s44 offen lds
 s_add_u32 s44, s44, s95
 s_mov_b32 m0, s40
 s_addk_i32 s40, 4096
 buffer_load_dwordx4 v3, s[16:19], s44 offen lds
 s_add_u32 s44, s44, s95
 s_waitcnt vmcnt(14) lgkmcnt(0)
 s_waitcnt vmcnt(10)
 v_lshl_or_b32 v96, v32, 7, v7
 v_lshl_or_b32 v100, v33, 7, v8
 v_lshl_or_b32 v97, v36, 7, v7
 v_lshl_or_b32 v101, v37, 7, v8
 v_lshl_or_b32 v96, v34, 11, v96
 v_lshl_or_b32 v100, v35, 11, v100
 v_lshl_or_b32 v97, v38, 11, v97
 v_lshl_or_b32 v101, v39, 11, v101
 s_waitcnt vmcnt(6)
 v_lshl_or_b32 v98, v40, 7, v7
 v_lshl_or_b32 v102, v41, 7, v8
 v_lshl_or_b32 v99, v44, 7, v7
 v_lshl_or_b32 v103, v45, 7, v8
 v_lshl_or_b32 v98, v42, 11, v98
 v_lshl_or_b32 v102, v43, 11, v102
 v_lshl_or_b32 v99, v46, 11, v99
 v_lshl_or_b32 v103, v47, 11, v103
 s_barrier
 s_mov_b32 m0, s41
 s_addk_i32 s41, 4096
 buffer_load_dwordx4 v3, s[16:19], s45 offen lds
 s_add_u32 s45, s45, s95
 s_mov_b32 m0, s41
 s_addk_i32 s41, 4096
 buffer_load_dwordx4 v3, s[16:19], s45 offen lds
 s_add_u32 s45, s45, s95
 s_mov_b32 m0, s41
 s_addk_i32 s41, 4096
 buffer_load_dwordx4 v3, s[16:19], s45 offen lds
 s_add_u32 s45, s45, s95
 s_mov_b32 m0, s41
 s_addk_i32 s41, 4096
 buffer_load_dwordx4 v3, s[16:19], s45 offen lds
 s_add_u32 s45, s45, s95
 s_waitcnt vmcnt(4)
 ds_write_b128 v4, v[96:99] offset:0
 ds_write_b128 v4, v[100:103] offset:128
 s_cmp_eq_u32 s32, 0
 s_cbranch_scc1 L_e6
 s_mov_b32 m0, s43
 s_add_u32 s3, s33, 331776
 buffer_load_dwordx4 v3, s[16:19], s3 offen lds
 s_add_u32 s33, s33, 128
 s_cmp_eq_u32 s33, 1152
 s_cselect_b32 s33, 0, s33
 s_xor_b32 s43, s43, 2048
L_e6:
 s_waitcnt lgkmcnt(0)
 s_barrier
 s_mov_b32 m0, s41
 s_addk_i32 s41, 4096
 buffer_load_dwordx4 v3, s[16:19], s45 offen lds
 s_add_u32 s45, s45, s95
 s_mov_b32 m0, s41
 s_addk_i32 s41, 4096
 buffer_load_dwordx4 v3, s[16:19], s45 offen lds
 s_add_u32 s45, s45, s95
 s_mov_b32 m0, s40
 s_addk_i32 s40, 4096
 buffer_load_dwordx4 v3, s[16:19], s44 offen lds
 s_add_u32 s44, s44, s95
 s_mov_b32 m0, s41
 s_addk_i32 s41, 4096
 buffer_load_dwordx4 v3, s[16:19], s45 offen lds
 s_add_u32 s45, s45, s95
 s_mov_b32 m0, s40
 s_addk_i32 s40, 4096
 buffer_load_dwordx4 v3, s[16:19], s44 offen lds
 s_add_u32 s44, s44, s95
 s_mov_b32 m0, s41
 s_addk_i32 s41, 4096
 buffer_load_dwordx4 v3, s[16:19], s45 offen lds
 s_add_u32 s45, s45, s95
 s_mov_b32 m0, s40
 s_addk_i32 s40, 4096
 buffer_load_dwordx4 v3, s[16:19], s44 offen lds
 s_add_u32 s44, s44, s95
 s_mov_b32 m0, s41
 s_addk_i32 s41, 4096
 buffer_load_dwordx4 v3, s[16:19], s45 offen lds
 s_add_u32 s45, s45, s95
 s_waitcnt vmcnt(8)
 s_barrier
 s_add_u32 s43, s56, 0
 s_cmp_eq_u32 s32, 0
 s_cbranch_scc1 L_e7
 s_mov_b32 m0, s43
 s_add_u32 s3, s33, 331776
 buffer_load_dwordx4 v3, s[16:19], s3 offen lds
 s_add_u32 s33, s33, 128
 s_cmp_eq_u32 s33, 1152
 s_cselect_b32 s33, 0, s33
 s_xor_b32 s43, s43, 2048
L_e7:
 s_mov_b32 s54, 0
 s_mov_b32 s55, 147456
 s_cmp_lt_u32 s36, 2
 s_cselect_b32 s46, 18, 17
 s_mul_i32 s46, s46, s55
 s_mov_b32 s47, 10
L_fw:
 s_waitcnt vmcnt(7)
 s_movk_i32 s42, 4096
 s_barrier
 ds_read_b128 v[128:131], v5 offset:0
 s_add_u32 s47, s47, 1
 s_cmp_eq_u32 s47, 12
 s_cselect_b32 s3, 4294922240, s42
 s_cselect_b32 s47, 0, s47
 v_add_u32 v5, s3, v5
 s_waitcnt lgkmcnt(0)
 buffer_store_dwordx4 v[128:131], v6, s[24:27], s54 offen sc0 sc1
 s_add_u32 s54, s54, s55
 s_waitcnt vmcnt(7)
 s_movk_i32 s42, 4096
 s_barrier
 ds_read_b128 v[128:131], v5 offset:0
 s_add_u32 s47, s47, 1
 s_cmp_eq_u32 s47, 12
 s_cselect_b32 s3, 4294922240, s42
 s_cselect_b32 s47, 0, s47
 v_add_u32 v5, s3, v5
 s_waitcnt lgkmcnt(0)
 buffer_store_dwordx4 v[128:131], v6, s[24:27], s54 offen sc0 sc1
 s_add_u32 s54, s54, s55
 s_waitcnt vmcnt(2)
 s_movk_i32 s42, 8192
 s_mov_b32 s34, 8
L_fw2:
 s_barrier
 ds_read_b128 v[128:131], v5 offset:0
 ds_read_b128 v[132:135], v5 offset:4096
 s_add_u32 s47, s47, 2
 s_cmp_eq_u32 s47, 12
 s_cselect_b32 s3, 4294926336, s42
 s_cselect_b32 s47, 0, s47
 v_add_u32 v5, s3, v5
 s_waitcnt lgkmcnt(1)
 buffer_store_dwordx4 v[128:131], v6, s[24:27], s54 offen sc0 sc1
 s_add_u32 s54, s54, s55
 s_cmp_eq_u32 s54, s46
 s_cbranch_scc1 L_p_done
 s_waitcnt lgkmcnt(0)
 buffer_store_dwordx4 v[132:135], v6, s[24:27], s54 offen sc0 sc1
 s_add_u32 s54, s54, s55
 s_sub_u32 s34, s34, 1
 s_cmp_lg_u32 s34, 0
 s_cbranch_scc1 L_fw2
L_p_done:
 s_endpgm
s_endpgm
.section .rodata,"a"
.p2align 6
.amdhsa_kernel standalone__normalfloat_lut_nf4__prompt_kernel
  .amdhsa_next_free_vgpr 256
  .amdhsa_next_free_sgpr 102
  .amdhsa_accum_offset 256
  .amdhsa_group_segment_fixed_size 0
  .amdhsa_kernarg_size 48
  .amdhsa_user_sgpr_count 2
  .amdhsa_user_sgpr_kernarg_segment_ptr 1
  .amdhsa_system_sgpr_workgroup_id_x 1
  .amdhsa_float_denorm_mode_32 3
.end_amdhsa_kernel
```
